```python
import torch

def _softmax(x, axis=-1):
    return torch.softmax(x, dim=axis)
def _gelu(x):
    return torch.nn.functional.gelu(x, approximate="tanh")
def _silu(x):
    return torch.nn.functional.silu(x)
def _sigmoid(x):
    return torch.sigmoid(x)
def _layernorm(x, axis=-1, eps=1e-5):
    m = x.mean(dim=axis, keepdim=True)
    v = x.var(dim=axis, keepdim=True, unbiased=False)
    return (x - m) / torch.sqrt(v + eps)
def _scatter_add(tgt, idx, src, axis=0):
    return tgt.clone().index_add_(axis, idx, src)
def _segment_sum(src, seg, n):
    out = torch.zeros((n,) + src.shape[1:], dtype=src.dtype)
    return out.index_add_(0, seg, src)
def _pad(x, pw):
    flat = tuple(v for pair in reversed(pw) for v in pair)
    return torch.nn.functional.pad(x, flat)

kernel_name = 'concat_heads__gqa_block_cached__gqa_block_cached__near_ridge'

def setup_inputs():

    _w = (lambda a: (lambda t: t.to(torch.bfloat16) if t.is_floating_point() else t)(torch.as_tensor(a)))
    def _A_setup():
        B, Sq, D = 8, 48, 512
        Hq, Hkv, Sk, Dh = 32, 8, 1024, 128
        assert Hq % Hkv == 0, (Hq, Hkv)
        return {
            "x": _w((lambda *s: torch.randn(*s, dtype=torch.bfloat16) * 0.8)(B, Sq, D)),
            "k_cache": _w((lambda *s: torch.randn(*s, dtype=torch.bfloat16) * 0.8)(B, Hkv, Sk, Dh)),
            "v_cache": _w((lambda *s: torch.randn(*s, dtype=torch.bfloat16) * 0.05)(B, Hkv, Sk, Dh)),
            "wq": _w((lambda *s: torch.randn(*s, dtype=torch.bfloat16) * 0.8)(D, Hq * Dh) * (D ** -0.5)),
            "wo": _w((lambda *s: torch.randn(*s, dtype=torch.bfloat16) * 0.05)(Hq * Dh, D) * ((Hq * Dh) ** -0.5)),
        }
    _A_in = _A_setup()

    def _B_setup():
        B, Sq, D = 8, 48, 512
        Hq, Hkv, Sk, Dh = 32, 8, 1024, 128
        assert Hq % Hkv == 0, (Hq, Hkv)
        return {
            "x": _w((lambda *s: torch.randn(*s, dtype=torch.bfloat16) * 0.8)(B, Sq, D)),
            "k_cache": _w((lambda *s: torch.randn(*s, dtype=torch.bfloat16) * 0.8)(B, Hkv, Sk, Dh)),
            "v_cache": _w((lambda *s: torch.randn(*s, dtype=torch.bfloat16) * 0.05)(B, Hkv, Sk, Dh)),
            "wq": _w((lambda *s: torch.randn(*s, dtype=torch.bfloat16) * 0.8)(D, Hq * Dh) * (D ** -0.5)),
            "wo": _w((lambda *s: torch.randn(*s, dtype=torch.bfloat16) * 0.05)(Hq * Dh, D) * ((Hq * Dh) ** -0.5)),
        }
    _B_in = _B_setup()

    return {
        "A_x": _A_in["x"],
        "A_k_cache": _A_in["k_cache"],
        "A_v_cache": _A_in["v_cache"],
        "A_wq": _A_in["wq"],
        "A_wo": _A_in["wo"],
        "B_x": _B_in["x"],
        "B_k_cache": _B_in["k_cache"],
        "B_v_cache": _B_in["v_cache"],
        "B_wq": _B_in["wq"],
        "B_wo": _B_in["wo"],
    }

def reference(A_x, A_k_cache, A_v_cache, A_wq, A_wo, B_x, B_k_cache, B_v_cache, B_wq, B_wo):
    def _A_ref(x, k_cache, v_cache, wq, wo):
        B, Sq, D = x.shape
        Hq, Dh = 32, 128
        Hkv = k_cache.shape[1]
        rep = Hq // Hkv
        q = (lambda x, *d: x.permute(*d))((x @ wq).reshape(B, Sq, Hq, Dh), 0, 2, 1, 3)
        k = (lambda x, n, axis: torch.repeat_interleave(x, n, dim=axis))(k_cache, rep, axis=1)
        v = (lambda x, n, axis: torch.repeat_interleave(x, n, dim=axis))(v_cache, rep, axis=1)
        scores = torch.einsum("bhqd,bhkd->bhqk", q, k) * (Dh ** -0.5)
        p = _softmax(scores, axis=-1)
        o = torch.einsum("bhqk,bhkd->bhqd", p, v)
        return (lambda x, *d: x.permute(*d))(o, 0, 2, 1, 3).reshape(B, Sq, Hq * Dh) @ wo

    def _B_ref(x, k_cache, v_cache, wq, wo):
        B, Sq, D = x.shape
        Hq, Dh = 32, 128
        Hkv = k_cache.shape[1]
        rep = Hq // Hkv
        q = (lambda x, *d: x.permute(*d))((x @ wq).reshape(B, Sq, Hq, Dh), 0, 2, 1, 3)
        k = (lambda x, n, axis: torch.repeat_interleave(x, n, dim=axis))(k_cache, rep, axis=1)
        v = (lambda x, n, axis: torch.repeat_interleave(x, n, dim=axis))(v_cache, rep, axis=1)
        scores = torch.einsum("bhqd,bhkd->bhqk", q, k) * (Dh ** -0.5)
        p = _softmax(scores, axis=-1)
        o = torch.einsum("bhqk,bhkd->bhqd", p, v)
        return (lambda x, *d: x.permute(*d))(o, 0, 2, 1, 3).reshape(B, Sq, Hq * Dh) @ wo

    a = _A_ref(A_x, A_k_cache, A_v_cache, A_wq, A_wo)
    b = _B_ref(B_x, B_k_cache, B_v_cache, B_wq, B_wo)
    return torch.concatenate([a, b], axis=-1)
```

```asm
; @launch grid=(256,1,1) block=(512,1,1) lds=163840
.amdgcn_target "amdgcn-amd-amdhsa--gfx950"
.text
.globl concat_heads__gqa_block_cached__gqa_block_cached__near_ridge_kernel
.p2align 8
.type concat_heads__gqa_block_cached__gqa_block_cached__near_ridge_kernel,@function
concat_heads__gqa_block_cached__gqa_block_cached__near_ridge_kernel:
    s_cmp_ge_u32 s2, 256
    s_cbranch_scc1 L_END
    s_load_dwordx16 s[64:79], s[0:1], 0
    s_load_dwordx8 s[80:87], s[0:1], 64
    s_load_dwordx2 s[88:89], s[0:1], 96
    s_and_b32 s32, s2, 7
    s_lshr_b32 s33, s2, 3
    s_lshr_b32 s34, s33, 4
    s_lshl_b32 s32, s32, 1
    s_add_u32 s32, s32, s34
    s_lshr_b32 s6, s32, 3
    s_and_b32 s7, s32, 7
    s_bfe_u32 s4, s33, 0x30001
    s_and_b32 s34, s33, 1
    s_lshl_b32 s5, s7, 1
    s_add_u32 s5, s5, s34
    v_lshrrev_b32 v1, 6, v0
    v_and_b32 v0, 63, v0
    v_readfirstlane_b32 s3, v1
    s_lshl_b32 s38, s6, 3
    s_add_u32 s38, s38, s4
    s_waitcnt lgkmcnt(0)
    s_cmp_eq_u32 s6, 0
    s_cselect_b32 s62, s70, s80
    s_cselect_b32 s63, s71, s81
    s_cselect_b32 s56, s64, s74
    s_cselect_b32 s57, s65, s75
    s_cselect_b32 s58, s66, s76
    s_cselect_b32 s59, s67, s77
    s_cselect_b32 s60, s68, s78
    s_cselect_b32 s61, s69, s79
    s_cselect_b32 s90, s72, s82
    s_cselect_b32 s91, s73, s83
    s_cmp_ge_u32 s3, 4
    s_cbranch_scc1 L_LOADER
    s_cmp_eq_u32 s3, 3
    s_cbranch_scc1 L_W3_START
    s_mul_i32 s32, s4, 49152
    s_add_u32 s8, s56, s32
    s_addc_u32 s9, s57, 0
    s_mov_b32 s10, 0xc000
    s_mov_b32 s11, 0x20000
    v_lshrrev_b32 v2, 3, v0
    v_and_b32 v3, 7, v0
    v_lshrrev_b32 v4, 4, v0
    v_xor_b32 v3, v3, v4
    v_lshlrev_b32_e64 v3, 4, v3
    v_lshl_add_u32 v2, v2, 10, v3
    v_xor_b32_e64 v3, 64, v2
    v_add_u32 v3, 7168, v3
    s_lshl_b32 s33, s3, 14
    s_lshl_b32 s35, s3, 11
    s_add_u32 s35, s35, 114688
    s_add_u32 s32, s4, 0
    s_and_b32 s32, s32, 7
    s_mul_i32 s36, s32, 6144
    s_lshl_b32 s34, s32, 7
    s_add_u32 m0, s36, s35
    s_add_u32 s34, s34, s33
    buffer_load_dwordx4 v2, s[8:11], s34 offen  lds
    buffer_load_dwordx4 v3, s[8:11], s34 offen offset:1024  lds
    s_add_u32 s32, s4, 1
    s_and_b32 s32, s32, 7
    s_mul_i32 s36, s32, 6144
    s_lshl_b32 s34, s32, 7
    s_add_u32 m0, s36, s35
    s_add_u32 s34, s34, s33
    buffer_load_dwordx4 v2, s[8:11], s34 offen  lds
    buffer_load_dwordx4 v3, s[8:11], s34 offen offset:1024  lds
    s_add_u32 s32, s4, 2
    s_and_b32 s32, s32, 7
    s_mul_i32 s36, s32, 6144
    s_lshl_b32 s34, s32, 7
    s_add_u32 m0, s36, s35
    s_add_u32 s34, s34, s33
    buffer_load_dwordx4 v2, s[8:11], s34 offen  lds
    buffer_load_dwordx4 v3, s[8:11], s34 offen offset:1024  lds
    s_add_u32 s32, s4, 3
    s_and_b32 s32, s32, 7
    s_mul_i32 s36, s32, 6144
    s_lshl_b32 s34, s32, 7
    s_add_u32 m0, s36, s35
    s_add_u32 s34, s34, s33
    buffer_load_dwordx4 v2, s[8:11], s34 offen  lds
    buffer_load_dwordx4 v3, s[8:11], s34 offen offset:1024  lds
    s_add_u32 s32, s4, 4
    s_and_b32 s32, s32, 7
    s_mul_i32 s36, s32, 6144
    s_lshl_b32 s34, s32, 7
    s_add_u32 m0, s36, s35
    s_add_u32 s34, s34, s33
    buffer_load_dwordx4 v2, s[8:11], s34 offen  lds
    buffer_load_dwordx4 v3, s[8:11], s34 offen offset:1024  lds
    s_add_u32 s32, s4, 5
    s_and_b32 s32, s32, 7
    s_mul_i32 s36, s32, 6144
    s_lshl_b32 s34, s32, 7
    s_add_u32 m0, s36, s35
    s_add_u32 s34, s34, s33
    buffer_load_dwordx4 v2, s[8:11], s34 offen  lds
    buffer_load_dwordx4 v3, s[8:11], s34 offen offset:1024  lds
    s_add_u32 s32, s4, 6
    s_and_b32 s32, s32, 7
    s_mul_i32 s36, s32, 6144
    s_lshl_b32 s34, s32, 7
    s_add_u32 m0, s36, s35
    s_add_u32 s34, s34, s33
    buffer_load_dwordx4 v2, s[8:11], s34 offen  lds
    buffer_load_dwordx4 v3, s[8:11], s34 offen offset:1024  lds
    s_add_u32 s32, s4, 7
    s_and_b32 s32, s32, 7
    s_mul_i32 s36, s32, 6144
    s_lshl_b32 s34, s32, 7
    s_add_u32 m0, s36, s35
    s_add_u32 s34, s34, s33
    buffer_load_dwordx4 v2, s[8:11], s34 offen  lds
    buffer_load_dwordx4 v3, s[8:11], s34 offen offset:1024  lds
    s_branch L_WORK_SETUP
L_W3_START:
    s_cmp_lg_u32 s5, 0
    s_cbranch_scc1 L_WORK_SETUP
    s_mov_b32 s28, s88
    s_mov_b32 s29, s89
    s_mov_b32 s30, 0x10000000
    s_mov_b32 s31, 0x20000
    s_mov_b32 s96, s86
    s_mov_b32 s97, s87
    s_mov_b32 s98, 0x100
    s_mov_b32 s99, 0x20000
    s_lshl_b32 s32, s38, 8
    s_add_u32 s32, s32, 0xe00000
    s_lshl_b32 s33, s38, 4
    s_mov_b64 s[34:35], exec
    v_mov_b32 v2, 0
    v_mov_b32 v3, 1
    v_lshlrev_b32 v4, 7, v0
    s_mov_b64 exec, 3
    buffer_store_dword v2, v4, s[28:31], s32 offen sc1
    s_mov_b64 exec, 1
    s_waitcnt vmcnt(0)
    buffer_atomic_add v3, v2, s[96:99], s33 offen sc1
    s_mov_b64 exec, s[34:35]
L_WORK_SETUP:
    v_and_b32 v3, 15, v0
    v_lshrrev_b32_e64 v6, 4, v0
    v_bfe_u32 v7, v0, 2, 2
    v_and_b32 v8, 3, v0
    v_lshrrev_b32 v4, 1, v3
    v_xor_b32 v4, v6, v4
    v_lshlrev_b32 v4, 4, v4
    v_lshl_add_u32 v5, v3, 7, v4
    v_add_u32 v26, 0x1c000, v5
    v_xor_b32 v248, 64, v26
    v_and_b32 v4, 1, v6
    v_lshl_add_u32 v4, v4, 2, v7
    s_lshl_b32 s32, s3, 2
    v_xor_b32 v5, s32, v4
    v_lshlrev_b32_e64 v5, 5, v5
    v_lshl_add_u32 v1, v6, 3, v7
    v_lshl_add_u32 v5, v1, 9, v5
    v_lshl_add_u32 v22, v8, 3, v5
    v_xor_b32 v23, 32, v22
    v_xor_b32 v24, 64, v22
    v_xor_b32 v25, 96, v22
L_X_LANDED:
    s_add_u32 s32, s4, 0
    s_and_b32 s32, s32, 7
    s_mul_i32 s42, s32, 6144
    v_add_u32_e64 v27, s42, v26
    s_waitcnt vmcnt(14)
    s_barrier
    ds_read_b64_tr_b16 v[128:129], v22 offset:0
    ds_read_b64_tr_b16 v[130:131], v22 offset:2048
    ds_read_b128 v[160:163], v27 offset:0
    ds_read_b128 v[164:167], v27 offset:2048
    ds_read_b128 v[168:171], v27 offset:4096
    ds_read_b64_tr_b16 v[132:133], v23 offset:0
    ds_read_b64_tr_b16 v[134:135], v23 offset:2048
    ds_read_b64_tr_b16 v[136:137], v24 offset:0
    ds_read_b64_tr_b16 v[138:139], v24 offset:2048
    ds_read_b64_tr_b16 v[140:141], v25 offset:0
    ds_read_b64_tr_b16 v[142:143], v25 offset:2048
    v_add_u32_e64 v9, s42, v248
    v_add_u32 v232, 0x10000, v22
    v_add_u32 v233, 0x10000, v23
    v_add_u32 v234, 0x10000, v24
    v_add_u32 v235, 0x10000, v25
    s_waitcnt lgkmcnt(0)
    s_barrier
    v_mfma_f32_16x16x32_bf16 v[32:35], v[128:131], v[160:163], 0
    ds_read_b64_tr_b16 v[144:145], v22 offset:16384
    v_mfma_f32_16x16x32_bf16 v[36:39], v[128:131], v[164:167], 0
    ds_read_b64_tr_b16 v[146:147], v22 offset:18432
    ds_read_b128 v[172:175], v9 offset:0
    v_mfma_f32_16x16x32_bf16 v[40:43], v[128:131], v[168:171], 0
    ds_read_b128 v[176:179], v9 offset:2048
    v_mfma_f32_16x16x32_bf16 v[44:47], v[132:135], v[160:163], 0
    ds_read_b128 v[180:183], v9 offset:4096
    ds_read_b64_tr_b16 v[148:149], v23 offset:16384
    v_mfma_f32_16x16x32_bf16 v[48:51], v[132:135], v[164:167], 0
    ds_read_b64_tr_b16 v[150:151], v23 offset:18432
    v_mfma_f32_16x16x32_bf16 v[52:55], v[132:135], v[168:171], 0
    ds_read_b64_tr_b16 v[152:153], v24 offset:16384
    ds_read_b64_tr_b16 v[154:155], v24 offset:18432
    v_mfma_f32_16x16x32_bf16 v[56:59], v[136:139], v[160:163], 0
    ds_read_b64_tr_b16 v[156:157], v25 offset:16384
    v_mfma_f32_16x16x32_bf16 v[60:63], v[136:139], v[164:167], 0
    ds_read_b64_tr_b16 v[158:159], v25 offset:18432
    s_add_u32 s32, s4, 1
    s_and_b32 s32, s32, 7
    v_mfma_f32_16x16x32_bf16 v[192:195], v[136:139], v[168:171], 0
    s_mul_i32 s42, s32, 6144
    v_add_u32 v27, s42, v26
    s_lshl_b32 s35, s3, 1
    v_mfma_f32_16x16x32_bf16 v[196:199], v[140:143], v[160:163], 0
    v_xor_b32 v5, s35, v4
    v_lshlrev_b32 v5, 5, v5
    v_lshl_add_u32 v5, v1, 8, v5
    v_mfma_f32_16x16x32_bf16 v[200:203], v[140:143], v[164:167], 0
    v_lshl_add_u32 v244, v8, 3, v5
    v_mul_u32_u24 v5, 272, v3
    v_lshl_add_u32 v4, v6, 4, v5
    v_mfma_f32_16x16x32_bf16 v[204:207], v[140:143], v[168:171], 0
    v_add_u32 v240, 0x18000, v4
    v_lshl_add_u32 v4, v6, 3, v5
    s_waitcnt lgkmcnt(0)
    s_waitcnt vmcnt(12)
    s_barrier
    v_mfma_f32_16x16x32_bf16 v[32:35], v[144:147], v[172:175], v[32:35]
    ds_read_b64_tr_b16 v[128:129], v22 offset:32768
    v_mfma_f32_16x16x32_bf16 v[36:39], v[144:147], v[176:179], v[36:39]
    ds_read_b64_tr_b16 v[130:131], v22 offset:34816
    v_mfma_f32_16x16x32_bf16 v[40:43], v[144:147], v[180:183], v[40:43]
    ds_read_b128 v[160:163], v27 offset:0
    ds_read_b128 v[164:167], v27 offset:2048
    v_mfma_f32_16x16x32_bf16 v[44:47], v[148:151], v[172:175], v[44:47]
    ds_read_b128 v[168:171], v27 offset:4096
    v_mfma_f32_16x16x32_bf16 v[48:51], v[148:151], v[176:179], v[48:51]
    ds_read_b64_tr_b16 v[132:133], v23 offset:32768
    v_mfma_f32_16x16x32_bf16 v[52:55], v[148:151], v[180:183], v[52:55]
    ds_read_b64_tr_b16 v[134:135], v23 offset:34816
    ds_read_b64_tr_b16 v[136:137], v24 offset:32768
    v_mfma_f32_16x16x32_bf16 v[56:59], v[152:155], v[172:175], v[56:59]
    ds_read_b64_tr_b16 v[138:139], v24 offset:34816
    v_mfma_f32_16x16x32_bf16 v[60:63], v[152:155], v[176:179], v[60:63]
    ds_read_b64_tr_b16 v[140:141], v25 offset:32768
    ds_read_b64_tr_b16 v[142:143], v25 offset:34816
    v_mfma_f32_16x16x32_bf16 v[192:195], v[152:155], v[180:183], v[192:195]
    v_add_u32_e64 v9, s42, v248
    s_lshr_b32 s35, s3, 1
    v_mfma_f32_16x16x32_bf16 v[196:199], v[156:159], v[172:175], v[196:199]
    s_mul_i32 s35, s35, 13056
    s_and_b32 s36, s3, 1
    s_lshl_b32 s36, s36, 7
    v_mfma_f32_16x16x32_bf16 v[200:203], v[156:159], v[176:179], v[200:203]
    s_add_u32 s35, s35, s36
    s_add_u32 s35, s35, 131072
    v_add_u32 v236, s35, v4
    v_mfma_f32_16x16x32_bf16 v[204:207], v[156:159], v[180:183], v[204:207]
    v_and_b32 v1, 31, v0
    v_lshrrev_b32 v2, 5, v0
    s_waitcnt lgkmcnt(0)
    s_barrier
    v_mfma_f32_16x16x32_bf16 v[32:35], v[128:131], v[160:163], v[32:35]
    ds_read_b64_tr_b16 v[144:145], v22 offset:49152
    v_mfma_f32_16x16x32_bf16 v[36:39], v[128:131], v[164:167], v[36:39]
    ds_read_b64_tr_b16 v[146:147], v22 offset:51200
    ds_read_b128 v[172:175], v9 offset:0
    v_mfma_f32_16x16x32_bf16 v[40:43], v[128:131], v[168:171], v[40:43]
    ds_read_b128 v[176:179], v9 offset:2048
    v_mfma_f32_16x16x32_bf16 v[44:47], v[132:135], v[160:163], v[44:47]
    ds_read_b128 v[180:183], v9 offset:4096
    ds_read_b64_tr_b16 v[148:149], v23 offset:49152
    v_mfma_f32_16x16x32_bf16 v[48:51], v[132:135], v[164:167], v[48:51]
    ds_read_b64_tr_b16 v[150:151], v23 offset:51200
    v_mfma_f32_16x16x32_bf16 v[52:55], v[132:135], v[168:171], v[52:55]
    ds_read_b64_tr_b16 v[152:153], v24 offset:49152
    ds_read_b64_tr_b16 v[154:155], v24 offset:51200
    v_mfma_f32_16x16x32_bf16 v[56:59], v[136:139], v[160:163], v[56:59]
    ds_read_b64_tr_b16 v[156:157], v25 offset:49152
    v_mfma_f32_16x16x32_bf16 v[60:63], v[136:139], v[164:167], v[60:63]
    ds_read_b64_tr_b16 v[158:159], v25 offset:51200
    s_add_u32 s32, s4, 2
    s_and_b32 s32, s32, 7
    v_mfma_f32_16x16x32_bf16 v[192:195], v[136:139], v[168:171], v[192:195]
    s_mul_i32 s42, s32, 6144
    v_add_u32 v27, s42, v26
    v_xor_b32 v4, v2, v3
    v_mfma_f32_16x16x32_bf16 v[196:199], v[140:143], v[160:163], v[196:199]
    v_lshlrev_b32_e64 v4, 4, v4
    v_lshl_add_u32 v10, v1, 8, v4
    v_xor_b32_e64 v11, 32, v10
    v_mfma_f32_16x16x32_bf16 v[200:203], v[140:143], v[164:167], v[200:203]
    v_xor_b32_e64 v12, 64, v10
    v_xor_b32 v13, 96, v10
    v_xor_b32 v14, 128, v10
    v_mfma_f32_16x16x32_bf16 v[204:207], v[140:143], v[168:171], v[204:207]
    v_xor_b32 v15, 160, v10
    v_xor_b32 v16, 192, v10
    s_waitcnt lgkmcnt(0)
    s_waitcnt vmcnt(10)
    s_barrier
    v_mfma_f32_16x16x32_bf16 v[32:35], v[144:147], v[172:175], v[32:35]
    ds_read_b64_tr_b16 v[128:129], v232 offset:0
    v_mfma_f32_16x16x32_bf16 v[36:39], v[144:147], v[176:179], v[36:39]
    ds_read_b64_tr_b16 v[130:131], v232 offset:2048
    v_mfma_f32_16x16x32_bf16 v[40:43], v[144:147], v[180:183], v[40:43]
    ds_read_b128 v[160:163], v27 offset:0
    ds_read_b128 v[164:167], v27 offset:2048
    v_mfma_f32_16x16x32_bf16 v[44:47], v[148:151], v[172:175], v[44:47]
    ds_read_b128 v[168:171], v27 offset:4096
    v_mfma_f32_16x16x32_bf16 v[48:51], v[148:151], v[176:179], v[48:51]
    ds_read_b64_tr_b16 v[132:133], v233 offset:0
    v_mfma_f32_16x16x32_bf16 v[52:55], v[148:151], v[180:183], v[52:55]
    ds_read_b64_tr_b16 v[134:135], v233 offset:2048
    ds_read_b64_tr_b16 v[136:137], v234 offset:0
    v_mfma_f32_16x16x32_bf16 v[56:59], v[152:155], v[172:175], v[56:59]
    ds_read_b64_tr_b16 v[138:139], v234 offset:2048
    v_mfma_f32_16x16x32_bf16 v[60:63], v[152:155], v[176:179], v[60:63]
    ds_read_b64_tr_b16 v[140:141], v235 offset:0
    ds_read_b64_tr_b16 v[142:143], v235 offset:2048
    v_mfma_f32_16x16x32_bf16 v[192:195], v[152:155], v[180:183], v[192:195]
    v_add_u32 v9, s42, v248
    v_xor_b32 v17, 224, v10
    v_mfma_f32_16x16x32_bf16 v[196:199], v[156:159], v[172:175], v[196:199]
    v_mul_u32_u24 v4, 272, v1
    s_mul_i32 s35, s3, 8704
    v_add_u32_e64 v4, s35, v4
    v_mfma_f32_16x16x32_bf16 v[200:203], v[156:159], v[176:179], v[200:203]
    v_lshl_add_u32 v5, v2, 3, v4
    v_add_u32 v237, 0x18000, v5
    v_lshl_add_u32 v5, v2, 4, v4
    v_mfma_f32_16x16x32_bf16 v[204:207], v[156:159], v[180:183], v[204:207]
    v_add_u32 v241, 0x20000, v5
    v_lshl_add_u32 v1, v2, 2, v7
    s_waitcnt lgkmcnt(0)
    s_barrier
    v_mfma_f32_16x16x32_bf16 v[32:35], v[128:131], v[160:163], v[32:35]
    ds_read_b64_tr_b16 v[144:145], v232 offset:16384
    v_mfma_f32_16x16x32_bf16 v[36:39], v[128:131], v[164:167], v[36:39]
    ds_read_b64_tr_b16 v[146:147], v232 offset:18432
    ds_read_b128 v[172:175], v9 offset:0
    v_mfma_f32_16x16x32_bf16 v[40:43], v[128:131], v[168:171], v[40:43]
    ds_read_b128 v[176:179], v9 offset:2048
    v_mfma_f32_16x16x32_bf16 v[44:47], v[132:135], v[160:163], v[44:47]
    ds_read_b128 v[180:183], v9 offset:4096
    ds_read_b64_tr_b16 v[148:149], v233 offset:16384
    v_mfma_f32_16x16x32_bf16 v[48:51], v[132:135], v[164:167], v[48:51]
    ds_read_b64_tr_b16 v[150:151], v233 offset:18432
    v_mfma_f32_16x16x32_bf16 v[52:55], v[132:135], v[168:171], v[52:55]
    ds_read_b64_tr_b16 v[152:153], v234 offset:16384
    ds_read_b64_tr_b16 v[154:155], v234 offset:18432
    v_mfma_f32_16x16x32_bf16 v[56:59], v[136:139], v[160:163], v[56:59]
    ds_read_b64_tr_b16 v[156:157], v235 offset:16384
    v_mfma_f32_16x16x32_bf16 v[60:63], v[136:139], v[164:167], v[60:63]
    ds_read_b64_tr_b16 v[158:159], v235 offset:18432
    s_add_u32 s32, s4, 3
    s_and_b32 s32, s32, 7
    v_mfma_f32_16x16x32_bf16 v[192:195], v[136:139], v[168:171], v[192:195]
    s_mul_i32 s42, s32, 6144
    v_add_u32 v27, s42, v26
    v_and_b32 v4, 1, v6
    v_mfma_f32_16x16x32_bf16 v[196:199], v[140:143], v[160:163], v[196:199]
    v_lshlrev_b32 v4, 1, v4
    v_lshrrev_b32 v5, 1, v8
    v_add_u32_e64 v4, v4, v5
    v_mfma_f32_16x16x32_bf16 v[200:203], v[140:143], v[164:167], v[200:203]
    v_lshlrev_b32 v5, 2, v7
    v_xor_b32 v4, v4, v5
    v_lshlrev_b32_e64 v4, 4, v4
    v_mfma_f32_16x16x32_bf16 v[204:207], v[140:143], v[168:171], v[204:207]
    v_lshl_add_u32 v4, v1, 8, v4
    v_and_b32 v5, 1, v8
    s_waitcnt lgkmcnt(0)
    s_waitcnt vmcnt(8)
    s_barrier
    v_mfma_f32_16x16x32_bf16 v[32:35], v[144:147], v[172:175], v[32:35]
    ds_read_b64_tr_b16 v[128:129], v232 offset:32768
    v_mfma_f32_16x16x32_bf16 v[36:39], v[144:147], v[176:179], v[36:39]
    ds_read_b64_tr_b16 v[130:131], v232 offset:34816
    v_mfma_f32_16x16x32_bf16 v[40:43], v[144:147], v[180:183], v[40:43]
    ds_read_b128 v[160:163], v27 offset:0
    ds_read_b128 v[164:167], v27 offset:2048
    v_mfma_f32_16x16x32_bf16 v[44:47], v[148:151], v[172:175], v[44:47]
    ds_read_b128 v[168:171], v27 offset:4096
    v_mfma_f32_16x16x32_bf16 v[48:51], v[148:151], v[176:179], v[48:51]
    ds_read_b64_tr_b16 v[132:133], v233 offset:32768
    v_mfma_f32_16x16x32_bf16 v[52:55], v[148:151], v[180:183], v[52:55]
    ds_read_b64_tr_b16 v[134:135], v233 offset:34816
    ds_read_b64_tr_b16 v[136:137], v234 offset:32768
    v_mfma_f32_16x16x32_bf16 v[56:59], v[152:155], v[172:175], v[56:59]
    ds_read_b64_tr_b16 v[138:139], v234 offset:34816
    v_mfma_f32_16x16x32_bf16 v[60:63], v[152:155], v[176:179], v[60:63]
    ds_read_b64_tr_b16 v[140:141], v235 offset:32768
    ds_read_b64_tr_b16 v[142:143], v235 offset:34816
    v_mfma_f32_16x16x32_bf16 v[192:195], v[152:155], v[180:183], v[192:195]
    v_add_u32_e64 v9, s42, v248
    v_lshl_add_u32 v4, v5, 3, v4
    v_mfma_f32_16x16x32_bf16 v[196:199], v[156:159], v[172:175], v[196:199]
    v_add_u32 v18, 0x10000, v4
    v_xor_b32_e64 v19, 64, v18
    v_xor_b32 v20, 128, v18
    v_mfma_f32_16x16x32_bf16 v[200:203], v[156:159], v[176:179], v[200:203]
    v_xor_b32 v21, 192, v18
    v_lshlrev_b32 v247, 4, v0
    s_lshl_b32 s35, s38, 8
    v_mfma_f32_16x16x32_bf16 v[204:207], v[156:159], v[180:183], v[204:207]
    s_add_u32 s35, s35, s5
    s_lshl_b32 s36, s3, 4
    s_waitcnt lgkmcnt(0)
    s_barrier
    v_mfma_f32_16x16x32_bf16 v[32:35], v[128:131], v[160:163], v[32:35]
    ds_read_b64_tr_b16 v[144:145], v22 offset:0
    v_mfma_f32_16x16x32_bf16 v[36:39], v[128:131], v[164:167], v[36:39]
    ds_read_b64_tr_b16 v[146:147], v22 offset:2048
    ds_read_b128 v[172:175], v9 offset:0
    v_mfma_f32_16x16x32_bf16 v[40:43], v[128:131], v[168:171], v[40:43]
    ds_read_b128 v[176:179], v9 offset:2048
    v_mfma_f32_16x16x32_bf16 v[44:47], v[132:135], v[160:163], v[44:47]
    ds_read_b128 v[180:183], v9 offset:4096
    ds_read_b64_tr_b16 v[148:149], v23 offset:0
    v_mfma_f32_16x16x32_bf16 v[48:51], v[132:135], v[164:167], v[48:51]
    ds_read_b64_tr_b16 v[150:151], v23 offset:2048
    v_mfma_f32_16x16x32_bf16 v[52:55], v[132:135], v[168:171], v[52:55]
    ds_read_b64_tr_b16 v[152:153], v24 offset:0
    ds_read_b64_tr_b16 v[154:155], v24 offset:2048
    v_mfma_f32_16x16x32_bf16 v[56:59], v[136:139], v[160:163], v[56:59]
    ds_read_b64_tr_b16 v[156:157], v25 offset:0
    v_mfma_f32_16x16x32_bf16 v[60:63], v[136:139], v[164:167], v[60:63]
    ds_read_b64_tr_b16 v[158:159], v25 offset:2048
    s_add_u32 s32, s4, 4
    s_and_b32 s32, s32, 7
    v_mfma_f32_16x16x32_bf16 v[192:195], v[136:139], v[168:171], v[192:195]
    s_mul_i32 s42, s32, 6144
    v_add_u32 v27, s42, v26
    s_add_u32 s35, s35, s36
    v_mfma_f32_16x16x32_bf16 v[196:199], v[140:143], v[160:163], v[196:199]
    s_mul_i32 s43, s35, 3072
    s_mov_b32 s28, s88
    s_mov_b32 s29, s89
    v_mfma_f32_16x16x32_bf16 v[200:203], v[140:143], v[164:167], v[200:203]
    s_mov_b32 s30, 0x10000000
    s_mov_b32 s31, 0x20000
    s_mov_b32 s41, 0x45800000
    v_mfma_f32_16x16x32_bf16 v[204:207], v[140:143], v[168:171], v[204:207]
    v_mov_b32 v64, 0
    v_mov_b32_e64 v65, 0
    s_waitcnt lgkmcnt(0)
    s_waitcnt vmcnt(6)
    s_barrier
    v_mfma_f32_16x16x32_bf16 v[32:35], v[144:147], v[172:175], v[32:35]
    ds_read_b64_tr_b16 v[128:129], v22 offset:16384
    v_mfma_f32_16x16x32_bf16 v[36:39], v[144:147], v[176:179], v[36:39]
    ds_read_b64_tr_b16 v[130:131], v22 offset:18432
    v_mfma_f32_16x16x32_bf16 v[40:43], v[144:147], v[180:183], v[40:43]
    ds_read_b128 v[160:163], v27 offset:0
    ds_read_b128 v[164:167], v27 offset:2048
    v_mfma_f32_16x16x32_bf16 v[44:47], v[148:151], v[172:175], v[44:47]
    ds_read_b128 v[168:171], v27 offset:4096
    v_mfma_f32_16x16x32_bf16 v[48:51], v[148:151], v[176:179], v[48:51]
    ds_read_b64_tr_b16 v[132:133], v23 offset:16384
    v_mfma_f32_16x16x32_bf16 v[52:55], v[148:151], v[180:183], v[52:55]
    ds_read_b64_tr_b16 v[134:135], v23 offset:18432
    ds_read_b64_tr_b16 v[136:137], v24 offset:16384
    v_mfma_f32_16x16x32_bf16 v[56:59], v[152:155], v[172:175], v[56:59]
    ds_read_b64_tr_b16 v[138:139], v24 offset:18432
    v_mfma_f32_16x16x32_bf16 v[60:63], v[152:155], v[176:179], v[60:63]
    ds_read_b64_tr_b16 v[140:141], v25 offset:16384
    ds_read_b64_tr_b16 v[142:143], v25 offset:18432
    v_mfma_f32_16x16x32_bf16 v[192:195], v[152:155], v[180:183], v[192:195]
    v_add_u32 v9, s42, v248
    v_mov_b32 v66, 0
    v_mfma_f32_16x16x32_bf16 v[196:199], v[156:159], v[172:175], v[196:199]
    v_mov_b32 v67, 0
    v_mov_b32 v68, 0
    v_mov_b32_e64 v69, 0
    v_mfma_f32_16x16x32_bf16 v[200:203], v[156:159], v[176:179], v[200:203]
    v_mov_b32 v70, 0
    v_mov_b32 v71, 0
    v_mov_b32_e64 v72, 0
    v_mfma_f32_16x16x32_bf16 v[204:207], v[156:159], v[180:183], v[204:207]
    v_mov_b32 v73, 0
    v_mov_b32 v74, 0
    s_waitcnt lgkmcnt(0)
    s_barrier
    v_mfma_f32_16x16x32_bf16 v[32:35], v[128:131], v[160:163], v[32:35]
    ds_read_b64_tr_b16 v[144:145], v22 offset:32768
    v_mfma_f32_16x16x32_bf16 v[36:39], v[128:131], v[164:167], v[36:39]
    ds_read_b64_tr_b16 v[146:147], v22 offset:34816
    ds_read_b128 v[172:175], v9 offset:0
    v_mfma_f32_16x16x32_bf16 v[40:43], v[128:131], v[168:171], v[40:43]
    ds_read_b128 v[176:179], v9 offset:2048
    v_mfma_f32_16x16x32_bf16 v[44:47], v[132:135], v[160:163], v[44:47]
    ds_read_b128 v[180:183], v9 offset:4096
    ds_read_b64_tr_b16 v[148:149], v23 offset:32768
    v_mfma_f32_16x16x32_bf16 v[48:51], v[132:135], v[164:167], v[48:51]
    ds_read_b64_tr_b16 v[150:151], v23 offset:34816
    v_mfma_f32_16x16x32_bf16 v[52:55], v[132:135], v[168:171], v[52:55]
    ds_read_b64_tr_b16 v[152:153], v24 offset:32768
    ds_read_b64_tr_b16 v[154:155], v24 offset:34816
    v_mfma_f32_16x16x32_bf16 v[56:59], v[136:139], v[160:163], v[56:59]
    ds_read_b64_tr_b16 v[156:157], v25 offset:32768
    v_mfma_f32_16x16x32_bf16 v[60:63], v[136:139], v[164:167], v[60:63]
    ds_read_b64_tr_b16 v[158:159], v25 offset:34816
    s_add_u32 s32, s4, 5
    s_and_b32 s32, s32, 7
    v_mfma_f32_16x16x32_bf16 v[192:195], v[136:139], v[168:171], v[192:195]
    s_mul_i32 s42, s32, 6144
    v_add_u32 v27, s42, v26
    v_mov_b32 v75, 0
    v_mfma_f32_16x16x32_bf16 v[196:199], v[140:143], v[160:163], v[196:199]
    v_mov_b32 v76, 0
    v_mov_b32 v77, 0
    v_mov_b32_e64 v78, 0
    v_mfma_f32_16x16x32_bf16 v[200:203], v[140:143], v[164:167], v[200:203]
    v_mov_b32 v79, 0
    v_mov_b32 v80, 0
    v_mov_b32_e64 v81, 0
    v_mfma_f32_16x16x32_bf16 v[204:207], v[140:143], v[168:171], v[204:207]
    v_mov_b32 v82, 0
    v_mov_b32_e64 v83, 0
    s_waitcnt lgkmcnt(0)
    s_waitcnt vmcnt(4)
    s_barrier
    v_mfma_f32_16x16x32_bf16 v[32:35], v[144:147], v[172:175], v[32:35]
    ds_read_b64_tr_b16 v[128:129], v22 offset:49152
    v_mfma_f32_16x16x32_bf16 v[36:39], v[144:147], v[176:179], v[36:39]
    ds_read_b64_tr_b16 v[130:131], v22 offset:51200
    v_mfma_f32_16x16x32_bf16 v[40:43], v[144:147], v[180:183], v[40:43]
    ds_read_b128 v[160:163], v27 offset:0
    ds_read_b128 v[164:167], v27 offset:2048
    v_mfma_f32_16x16x32_bf16 v[44:47], v[148:151], v[172:175], v[44:47]
    ds_read_b128 v[168:171], v27 offset:4096
    v_mfma_f32_16x16x32_bf16 v[48:51], v[148:151], v[176:179], v[48:51]
    ds_read_b64_tr_b16 v[132:133], v23 offset:49152
    v_mfma_f32_16x16x32_bf16 v[52:55], v[148:151], v[180:183], v[52:55]
    ds_read_b64_tr_b16 v[134:135], v23 offset:51200
    ds_read_b64_tr_b16 v[136:137], v24 offset:49152
    v_mfma_f32_16x16x32_bf16 v[56:59], v[152:155], v[172:175], v[56:59]
    ds_read_b64_tr_b16 v[138:139], v24 offset:51200
    v_mfma_f32_16x16x32_bf16 v[60:63], v[152:155], v[176:179], v[60:63]
    ds_read_b64_tr_b16 v[140:141], v25 offset:49152
    ds_read_b64_tr_b16 v[142:143], v25 offset:51200
    v_mfma_f32_16x16x32_bf16 v[192:195], v[152:155], v[180:183], v[192:195]
    v_add_u32 v9, s42, v248
    v_mov_b32 v84, 0
    v_mfma_f32_16x16x32_bf16 v[196:199], v[156:159], v[172:175], v[196:199]
    v_mov_b32 v85, 0
    v_mov_b32 v86, 0
    v_mov_b32_e64 v87, 0
    v_mfma_f32_16x16x32_bf16 v[200:203], v[156:159], v[176:179], v[200:203]
    v_mov_b32 v88, 0
    v_mov_b32 v89, 0
    v_mov_b32_e64 v90, 0
    v_mfma_f32_16x16x32_bf16 v[204:207], v[156:159], v[180:183], v[204:207]
    v_mov_b32 v91, 0
    v_mov_b32 v92, 0
    s_waitcnt lgkmcnt(0)
    s_barrier
    v_mfma_f32_16x16x32_bf16 v[32:35], v[128:131], v[160:163], v[32:35]
    ds_read_b64_tr_b16 v[144:145], v232 offset:0
    v_mfma_f32_16x16x32_bf16 v[36:39], v[128:131], v[164:167], v[36:39]
    ds_read_b64_tr_b16 v[146:147], v232 offset:2048
    ds_read_b128 v[172:175], v9 offset:0
    v_mfma_f32_16x16x32_bf16 v[40:43], v[128:131], v[168:171], v[40:43]
    ds_read_b128 v[176:179], v9 offset:2048
    v_mfma_f32_16x16x32_bf16 v[44:47], v[132:135], v[160:163], v[44:47]
    ds_read_b128 v[180:183], v9 offset:4096
    ds_read_b64_tr_b16 v[148:149], v233 offset:0
    v_mfma_f32_16x16x32_bf16 v[48:51], v[132:135], v[164:167], v[48:51]
    ds_read_b64_tr_b16 v[150:151], v233 offset:2048
    v_mfma_f32_16x16x32_bf16 v[52:55], v[132:135], v[168:171], v[52:55]
    ds_read_b64_tr_b16 v[152:153], v234 offset:0
    ds_read_b64_tr_b16 v[154:155], v234 offset:2048
    v_mfma_f32_16x16x32_bf16 v[56:59], v[136:139], v[160:163], v[56:59]
    ds_read_b64_tr_b16 v[156:157], v235 offset:0
    v_mfma_f32_16x16x32_bf16 v[60:63], v[136:139], v[164:167], v[60:63]
    ds_read_b64_tr_b16 v[158:159], v235 offset:2048
    s_add_u32 s32, s4, 6
    s_and_b32 s32, s32, 7
    v_mfma_f32_16x16x32_bf16 v[192:195], v[136:139], v[168:171], v[192:195]
    s_mul_i32 s42, s32, 6144
    v_add_u32 v27, s42, v26
    v_mov_b32 v93, 0
    v_mfma_f32_16x16x32_bf16 v[196:199], v[140:143], v[160:163], v[196:199]
    v_mov_b32 v94, 0
    v_mov_b32 v95, 0
    v_mov_b32_e64 v96, 0
    v_mfma_f32_16x16x32_bf16 v[200:203], v[140:143], v[164:167], v[200:203]
    v_mov_b32 v97, 0
    v_mov_b32 v98, 0
    v_mov_b32_e64 v99, 0
    v_mfma_f32_16x16x32_bf16 v[204:207], v[140:143], v[168:171], v[204:207]
    v_mov_b32 v100, 0
    v_mov_b32_e64 v101, 0
    s_waitcnt lgkmcnt(0)
    s_waitcnt vmcnt(2)
    s_barrier
    v_mfma_f32_16x16x32_bf16 v[32:35], v[144:147], v[172:175], v[32:35]
    ds_read_b64_tr_b16 v[128:129], v232 offset:16384
    v_mfma_f32_16x16x32_bf16 v[36:39], v[144:147], v[176:179], v[36:39]
    ds_read_b64_tr_b16 v[130:131], v232 offset:18432
    v_mfma_f32_16x16x32_bf16 v[40:43], v[144:147], v[180:183], v[40:43]
    ds_read_b128 v[160:163], v27 offset:0
    ds_read_b128 v[164:167], v27 offset:2048
    v_mfma_f32_16x16x32_bf16 v[44:47], v[148:151], v[172:175], v[44:47]
    ds_read_b128 v[168:171], v27 offset:4096
    v_mfma_f32_16x16x32_bf16 v[48:51], v[148:151], v[176:179], v[48:51]
    ds_read_b64_tr_b16 v[132:133], v233 offset:16384
    v_mfma_f32_16x16x32_bf16 v[52:55], v[148:151], v[180:183], v[52:55]
    ds_read_b64_tr_b16 v[134:135], v233 offset:18432
    ds_read_b64_tr_b16 v[136:137], v234 offset:16384
    v_mfma_f32_16x16x32_bf16 v[56:59], v[152:155], v[172:175], v[56:59]
    ds_read_b64_tr_b16 v[138:139], v234 offset:18432
    v_mfma_f32_16x16x32_bf16 v[60:63], v[152:155], v[176:179], v[60:63]
    ds_read_b64_tr_b16 v[140:141], v235 offset:16384
    ds_read_b64_tr_b16 v[142:143], v235 offset:18432
    v_mfma_f32_16x16x32_bf16 v[192:195], v[152:155], v[180:183], v[192:195]
    v_add_u32 v9, s42, v248
    v_mov_b32 v102, 0
    v_mfma_f32_16x16x32_bf16 v[196:199], v[156:159], v[172:175], v[196:199]
    v_mov_b32 v103, 0
    v_mov_b32 v104, 0
    v_mov_b32_e64 v105, 0
    v_mfma_f32_16x16x32_bf16 v[200:203], v[156:159], v[176:179], v[200:203]
    v_mov_b32 v106, 0
    v_mov_b32 v107, 0
    v_mov_b32_e64 v108, 0
    v_mfma_f32_16x16x32_bf16 v[204:207], v[156:159], v[180:183], v[204:207]
    v_mov_b32 v109, 0
    v_mov_b32 v110, 0
    s_waitcnt lgkmcnt(0)
    s_barrier
    v_mfma_f32_16x16x32_bf16 v[32:35], v[128:131], v[160:163], v[32:35]
    ds_read_b64_tr_b16 v[144:145], v232 offset:32768
    v_mfma_f32_16x16x32_bf16 v[36:39], v[128:131], v[164:167], v[36:39]
    ds_read_b64_tr_b16 v[146:147], v232 offset:34816
    ds_read_b128 v[172:175], v9 offset:0
    v_mfma_f32_16x16x32_bf16 v[40:43], v[128:131], v[168:171], v[40:43]
    ds_read_b128 v[176:179], v9 offset:2048
    v_mfma_f32_16x16x32_bf16 v[44:47], v[132:135], v[160:163], v[44:47]
    ds_read_b128 v[180:183], v9 offset:4096
    ds_read_b64_tr_b16 v[148:149], v233 offset:32768
    v_mfma_f32_16x16x32_bf16 v[48:51], v[132:135], v[164:167], v[48:51]
    ds_read_b64_tr_b16 v[150:151], v233 offset:34816
    v_mfma_f32_16x16x32_bf16 v[52:55], v[132:135], v[168:171], v[52:55]
    ds_read_b64_tr_b16 v[152:153], v234 offset:32768
    ds_read_b64_tr_b16 v[154:155], v234 offset:34816
    v_mfma_f32_16x16x32_bf16 v[56:59], v[136:139], v[160:163], v[56:59]
    ds_read_b64_tr_b16 v[156:157], v235 offset:32768
    v_mfma_f32_16x16x32_bf16 v[60:63], v[136:139], v[164:167], v[60:63]
    ds_read_b64_tr_b16 v[158:159], v235 offset:34816
    s_add_u32 s32, s4, 7
    s_and_b32 s32, s32, 7
    v_mfma_f32_16x16x32_bf16 v[192:195], v[136:139], v[168:171], v[192:195]
    s_mul_i32 s42, s32, 6144
    v_add_u32 v27, s42, v26
    v_mov_b32 v111, 0
    v_mfma_f32_16x16x32_bf16 v[196:199], v[140:143], v[160:163], v[196:199]
    v_mov_b32 v112, 0
    v_mov_b32 v113, 0
    v_mov_b32_e64 v114, 0
    v_mfma_f32_16x16x32_bf16 v[200:203], v[140:143], v[164:167], v[200:203]
    v_mov_b32 v115, 0
    v_mov_b32 v116, 0
    v_mov_b32_e64 v117, 0
    v_mfma_f32_16x16x32_bf16 v[204:207], v[140:143], v[168:171], v[204:207]
    v_mov_b32 v118, 0
    v_mov_b32_e64 v119, 0
    s_waitcnt lgkmcnt(0)
    s_waitcnt vmcnt(0)
    s_barrier
    v_mfma_f32_16x16x32_bf16 v[32:35], v[144:147], v[172:175], v[32:35]
    ds_read_b64_tr_b16 v[128:129], v22 offset:0
    v_mfma_f32_16x16x32_bf16 v[36:39], v[144:147], v[176:179], v[36:39]
    ds_read_b64_tr_b16 v[130:131], v22 offset:2048
    v_mfma_f32_16x16x32_bf16 v[40:43], v[144:147], v[180:183], v[40:43]
    ds_read_b128 v[160:163], v27 offset:0
    ds_read_b128 v[164:167], v27 offset:2048
    v_mfma_f32_16x16x32_bf16 v[44:47], v[148:151], v[172:175], v[44:47]
    ds_read_b128 v[168:171], v27 offset:4096
    v_mfma_f32_16x16x32_bf16 v[48:51], v[148:151], v[176:179], v[48:51]
    ds_read_b64_tr_b16 v[132:133], v23 offset:0
    v_mfma_f32_16x16x32_bf16 v[52:55], v[148:151], v[180:183], v[52:55]
    ds_read_b64_tr_b16 v[134:135], v23 offset:2048
    ds_read_b64_tr_b16 v[136:137], v24 offset:0
    v_mfma_f32_16x16x32_bf16 v[56:59], v[152:155], v[172:175], v[56:59]
    ds_read_b64_tr_b16 v[138:139], v24 offset:2048
    v_mfma_f32_16x16x32_bf16 v[60:63], v[152:155], v[176:179], v[60:63]
    ds_read_b64_tr_b16 v[140:141], v25 offset:0
    ds_read_b64_tr_b16 v[142:143], v25 offset:2048
    v_mfma_f32_16x16x32_bf16 v[192:195], v[152:155], v[180:183], v[192:195]
    v_add_u32 v9, s42, v248
    v_mov_b32 v120, 0
    v_mfma_f32_16x16x32_bf16 v[196:199], v[156:159], v[172:175], v[196:199]
    v_mov_b32 v121, 0
    v_mov_b32 v122, 0
    v_mov_b32_e64 v123, 0
    v_mfma_f32_16x16x32_bf16 v[200:203], v[156:159], v[176:179], v[200:203]
    v_mov_b32 v124, 0
    v_mov_b32 v125, 0
    v_mov_b32_e64 v126, 0
    v_mfma_f32_16x16x32_bf16 v[204:207], v[156:159], v[180:183], v[204:207]
    v_mov_b32 v127, 0
    v_mov_b32 v30, 0
    s_waitcnt lgkmcnt(0)
    s_barrier
    v_mfma_f32_16x16x32_bf16 v[32:35], v[128:131], v[160:163], v[32:35]
    ds_read_b64_tr_b16 v[144:145], v22 offset:16384
    v_mfma_f32_16x16x32_bf16 v[36:39], v[128:131], v[164:167], v[36:39]
    ds_read_b64_tr_b16 v[146:147], v22 offset:18432
    v_mfma_f32_16x16x32_bf16 v[40:43], v[128:131], v[168:171], v[40:43]
    ds_read_b128 v[172:175], v9 offset:0
    v_mfma_f32_16x16x32_bf16 v[44:47], v[132:135], v[160:163], v[44:47]
    ds_read_b128 v[176:179], v9 offset:2048
    v_mfma_f32_16x16x32_bf16 v[48:51], v[132:135], v[164:167], v[48:51]
    ds_read_b128 v[180:183], v9 offset:4096
    v_mfma_f32_16x16x32_bf16 v[52:55], v[132:135], v[168:171], v[52:55]
    ds_read_b64_tr_b16 v[148:149], v23 offset:16384
    v_mfma_f32_16x16x32_bf16 v[56:59], v[136:139], v[160:163], v[56:59]
    ds_read_b64_tr_b16 v[150:151], v23 offset:18432
    v_mfma_f32_16x16x32_bf16 v[60:63], v[136:139], v[164:167], v[60:63]
    ds_read_b64_tr_b16 v[152:153], v24 offset:16384
    v_mfma_f32_16x16x32_bf16 v[192:195], v[136:139], v[168:171], v[192:195]
    ds_read_b64_tr_b16 v[154:155], v24 offset:18432
    v_mfma_f32_16x16x32_bf16 v[196:199], v[140:143], v[160:163], v[196:199]
    ds_read_b64_tr_b16 v[156:157], v25 offset:16384
    v_mfma_f32_16x16x32_bf16 v[200:203], v[140:143], v[164:167], v[200:203]
    ds_read_b64_tr_b16 v[158:159], v25 offset:18432
    v_mfma_f32_16x16x32_bf16 v[204:207], v[140:143], v[168:171], v[204:207]
    s_waitcnt lgkmcnt(0)
    s_barrier
    v_mfma_f32_16x16x32_bf16 v[32:35], v[144:147], v[172:175], v[32:35]
    v_mfma_f32_16x16x32_bf16 v[36:39], v[144:147], v[176:179], v[36:39]
    v_mfma_f32_16x16x32_bf16 v[40:43], v[144:147], v[180:183], v[40:43]
    v_mfma_f32_16x16x32_bf16 v[44:47], v[148:151], v[172:175], v[44:47]
    v_mfma_f32_16x16x32_bf16 v[48:51], v[148:151], v[176:179], v[48:51]
    v_mfma_f32_16x16x32_bf16 v[52:55], v[148:151], v[180:183], v[52:55]
    v_mfma_f32_16x16x32_bf16 v[56:59], v[152:155], v[172:175], v[56:59]
    v_mfma_f32_16x16x32_bf16 v[60:63], v[152:155], v[176:179], v[60:63]
    v_mfma_f32_16x16x32_bf16 v[192:195], v[152:155], v[180:183], v[192:195]
    v_mfma_f32_16x16x32_bf16 v[196:199], v[156:159], v[172:175], v[196:199]
    v_mfma_f32_16x16x32_bf16 v[200:203], v[156:159], v[176:179], v[200:203]
    v_mfma_f32_16x16x32_bf16 v[204:207], v[156:159], v[180:183], v[204:207]
    s_mov_b32 s34, 0x3e0293ee
    s_mov_b32 s35, 0x3e0293ee
    s_nop 5
    v_pk_mul_f32 v[32:33], v[32:33], s[34:35]
    v_pk_mul_f32 v[34:35], v[34:35], s[34:35]
    v_cvt_pk_bf16_f32 v32, v32, v33
    v_cvt_pk_bf16_f32 v33, v34, v35
    ds_write_b64 v236, v[32:33] offset:0
    v_pk_mul_f32 v[36:37], v[36:37], s[34:35]
    v_pk_mul_f32 v[38:39], v[38:39], s[34:35]
    v_cvt_pk_bf16_f32 v36, v36, v37
    v_cvt_pk_bf16_f32 v37, v38, v39
    ds_write_b64 v236, v[36:37] offset:4352
    v_pk_mul_f32 v[40:41], v[40:41], s[34:35]
    v_pk_mul_f32 v[42:43], v[42:43], s[34:35]
    v_cvt_pk_bf16_f32 v40, v40, v41
    v_cvt_pk_bf16_f32 v41, v42, v43
    ds_write_b64 v236, v[40:41] offset:8704
    v_pk_mul_f32 v[44:45], v[44:45], s[34:35]
    v_pk_mul_f32 v[46:47], v[46:47], s[34:35]
    v_cvt_pk_bf16_f32 v44, v44, v45
    v_cvt_pk_bf16_f32 v45, v46, v47
    ds_write_b64 v236, v[44:45] offset:32
    v_pk_mul_f32 v[48:49], v[48:49], s[34:35]
    v_pk_mul_f32 v[50:51], v[50:51], s[34:35]
    v_cvt_pk_bf16_f32 v48, v48, v49
    v_cvt_pk_bf16_f32 v49, v50, v51
    ds_write_b64 v236, v[48:49] offset:4384
    v_pk_mul_f32 v[52:53], v[52:53], s[34:35]
    v_pk_mul_f32 v[54:55], v[54:55], s[34:35]
    v_cvt_pk_bf16_f32 v52, v52, v53
    v_cvt_pk_bf16_f32 v53, v54, v55
    ds_write_b64 v236, v[52:53] offset:8736
    v_pk_mul_f32 v[56:57], v[56:57], s[34:35]
    v_pk_mul_f32 v[58:59], v[58:59], s[34:35]
    v_cvt_pk_bf16_f32 v56, v56, v57
    v_cvt_pk_bf16_f32 v57, v58, v59
    ds_write_b64 v236, v[56:57] offset:64
    v_pk_mul_f32 v[60:61], v[60:61], s[34:35]
    v_pk_mul_f32 v[62:63], v[62:63], s[34:35]
    v_cvt_pk_bf16_f32 v60, v60, v61
    v_cvt_pk_bf16_f32 v61, v62, v63
    ds_write_b64 v236, v[60:61] offset:4416
    v_pk_mul_f32 v[192:193], v[192:193], s[34:35]
    v_pk_mul_f32 v[194:195], v[194:195], s[34:35]
    v_cvt_pk_bf16_f32 v192, v192, v193
    v_cvt_pk_bf16_f32 v193, v194, v195
    ds_write_b64 v236, v[192:193] offset:8768
    v_pk_mul_f32 v[196:197], v[196:197], s[34:35]
    v_pk_mul_f32 v[198:199], v[198:199], s[34:35]
    v_cvt_pk_bf16_f32 v196, v196, v197
    v_cvt_pk_bf16_f32 v197, v198, v199
    ds_write_b64 v236, v[196:197] offset:96
    v_pk_mul_f32 v[200:201], v[200:201], s[34:35]
    v_pk_mul_f32 v[202:203], v[202:203], s[34:35]
    v_cvt_pk_bf16_f32 v200, v200, v201
    v_cvt_pk_bf16_f32 v201, v202, v203
    ds_write_b64 v236, v[200:201] offset:4448
    v_pk_mul_f32 v[204:205], v[204:205], s[34:35]
    v_pk_mul_f32 v[206:207], v[206:207], s[34:35]
    v_cvt_pk_bf16_f32 v204, v204, v205
    v_cvt_pk_bf16_f32 v205, v206, v207
    ds_write_b64 v236, v[204:205] offset:8800
    s_waitcnt lgkmcnt(0)
    s_barrier
    s_cmp_eq_u32 s3, 3
    s_cbranch_scc1 L_TRANS
    ds_read_b128 v[32:35], v241 offset:0
    ds_read_b128 v[36:39], v241 offset:32
    ds_read_b128 v[40:43], v241 offset:64
    ds_read_b128 v[44:47], v241 offset:96
    ds_read_b128 v[48:51], v241 offset:128
    ds_read_b128 v[52:55], v241 offset:160
    ds_read_b128 v[56:59], v241 offset:192
    ds_read_b128 v[60:63], v241 offset:224
    ds_read_b128 v[192:195], v10 offset:32768
    ds_read_b128 v[196:199], v11 offset:32768
    ds_read_b128 v[200:203], v12 offset:32768
    ds_read_b128 v[204:207], v13 offset:32768
    ds_read_b128 v[208:211], v14 offset:32768
    ds_read_b128 v[212:215], v15 offset:32768
    s_waitcnt lgkmcnt(6)
    s_waitcnt lgkmcnt(2)
    v_mfma_f32_32x32x16_bf16 v[128:143], v[192:195], v[32:35], 0
    ds_read_b128 v[216:219], v16 offset:32768
    v_mfma_f32_32x32x16_bf16 v[128:143], v[196:199], v[36:39], v[128:143]
    ds_read_b128 v[220:223], v17 offset:32768
    v_mfma_f32_32x32x16_bf16 v[128:143], v[200:203], v[40:43], v[128:143]
    v_mfma_f32_32x32x16_bf16 v[128:143], v[204:207], v[44:47], v[128:143]
    s_waitcnt lgkmcnt(0)
    v_mfma_f32_32x32x16_bf16 v[128:143], v[208:211], v[48:51], v[128:143]
    v_mfma_f32_32x32x16_bf16 v[128:143], v[212:215], v[52:55], v[128:143]
    v_mfma_f32_32x32x16_bf16 v[128:143], v[216:219], v[56:59], v[128:143]
    v_mfma_f32_32x32x16_bf16 v[128:143], v[220:223], v[60:63], v[128:143]
    s_barrier
    ds_read_b128 v[192:195], v10 offset:40960
    ds_read_b128 v[196:199], v11 offset:40960
    ds_read_b128 v[200:203], v12 offset:40960
    ds_read_b128 v[204:207], v13 offset:40960
    ds_read_b128 v[208:211], v14 offset:40960
    ds_read_b128 v[212:215], v15 offset:40960
    s_nop 15
    v_max3_f32 v228, v128, v129, v130
    v_max3_f32 v228, v228, v131, v132
    v_max3_f32 v228, v228, v133, v134
    v_max3_f32 v228, v228, v135, v136
    v_max3_f32 v228, v228, v137, v138
    v_max3_f32 v228, v228, v139, v140
    v_max3_f32 v228, v228, v141, v142
    v_max_f32 v228, v228, v143
    v_mov_b32 v31, v228
    s_nop 1
    v_permlane32_swap_b32 v228, v31
    s_nop 1
    v_max_f32 v228, v228, v31
    v_sub_f32 v160, 0, v228
    v_sub_f32 v161, 0, v228
    v_sub_f32 v162, 0, v228
    v_sub_f32 v163, 0, v228
    v_sub_f32 v164, 0, v228
    v_sub_f32 v165, 0, v228
    v_sub_f32 v166, 0, v228
    v_sub_f32 v167, 0, v228
    v_sub_f32 v168, 0, v228
    v_sub_f32 v169, 0, v228
    v_sub_f32 v170, 0, v228
    v_sub_f32 v171, 0, v228
    v_sub_f32 v172, 0, v228
    v_sub_f32 v173, 0, v228
    v_sub_f32 v174, 0, v228
    v_sub_f32 v175, 0, v228
    v_sub_f32 v128, v128, v228
    v_sub_f32 v129, v129, v228
    v_sub_f32 v130, v130, v228
    v_sub_f32 v131, v131, v228
    v_sub_f32 v132, v132, v228
    v_sub_f32 v133, v133, v228
    v_sub_f32 v134, v134, v228
    v_sub_f32 v135, v135, v228
    v_sub_f32 v136, v136, v228
    v_sub_f32 v137, v137, v228
    v_sub_f32 v138, v138, v228
    v_sub_f32 v139, v139, v228
    v_sub_f32 v140, v140, v228
    v_sub_f32 v141, v141, v228
    v_sub_f32 v142, v142, v228
    v_sub_f32 v143, v143, v228
    s_nop 1
    s_waitcnt lgkmcnt(2)
    v_mfma_f32_32x32x16_bf16 v[144:159], v[192:195], v[32:35], v[160:175]
    ds_read_b128 v[216:219], v16 offset:40960
    v_exp_f32_e64 v224, v128
    v_mfma_f32_32x32x16_bf16 v[144:159], v[196:199], v[36:39], v[144:159]
    ds_read_b128 v[220:223], v17 offset:40960
    v_exp_f32 v225, v129
    v_exp_f32 v226, v130
    v_mfma_f32_32x32x16_bf16 v[144:159], v[200:203], v[40:43], v[144:159]
    v_add_f32 v28, v224, v225
    v_exp_f32 v227, v131
    v_cvt_pk_bf16_f32 v176, v224, v225
    v_mfma_f32_32x32x16_bf16 v[144:159], v[204:207], v[44:47], v[144:159]
    v_exp_f32 v224, v132
    v_add_f32 v29, v226, v227
    v_exp_f32 v225, v133
    s_waitcnt lgkmcnt(0)
    v_mfma_f32_32x32x16_bf16 v[144:159], v[208:211], v[48:51], v[144:159]
    v_cvt_pk_bf16_f32 v177, v226, v227
    v_exp_f32 v226, v134
    v_add_f32 v28, v28, v224
    v_mfma_f32_32x32x16_bf16 v[144:159], v[212:215], v[52:55], v[144:159]
    v_add_f32 v29, v29, v225
    v_exp_f32 v227, v135
    v_cvt_pk_bf16_f32 v178, v224, v225
    v_mfma_f32_32x32x16_bf16 v[144:159], v[216:219], v[56:59], v[144:159]
    v_exp_f32 v224, v136
    v_add_f32 v28, v28, v226
    v_add_f32_e64 v29, v29, v227
    v_mfma_f32_32x32x16_bf16 v[144:159], v[220:223], v[60:63], v[144:159]
    v_exp_f32_e64 v225, v137
    v_cvt_pk_bf16_f32 v179, v226, v227
    v_exp_f32 v226, v138
    v_add_f32 v28, v28, v224
    v_add_f32 v29, v29, v225
    v_exp_f32 v227, v139
    v_cvt_pk_bf16_f32 v180, v224, v225
    v_exp_f32 v224, v140
    v_add_f32_e64 v28, v28, v226
    s_barrier
    ds_read_b128 v[192:195], v10 offset:49152
    v_add_f32 v29, v29, v227
    v_exp_f32 v225, v141
    ds_read_b128 v[196:199], v11 offset:49152
    v_cvt_pk_bf16_f32 v181, v226, v227
    v_exp_f32 v226, v142
    v_add_f32 v28, v28, v224
    ds_read_b128 v[200:203], v12 offset:49152
    v_add_f32 v29, v29, v225
    v_exp_f32 v227, v143
    ds_read_b128 v[204:207], v13 offset:49152
    v_cvt_pk_bf16_f32 v182, v224, v225
    v_add_f32 v28, v28, v226
    v_add_f32 v29, v29, v227
    ds_read_b128 v[208:211], v14 offset:49152
    v_cvt_pk_bf16_f32 v183, v226, v227
    v_add_f32 v28, v28, v29
    v_cmp_nge_f32 vcc, s41, v28
    ds_read_b128 v[212:215], v15 offset:49152
    s_cbranch_vccnz L_RARE_0
L_RARE_0_BACK:
    v_add_f32 v30, v30, v28
    s_mov_b32 s40, 0
.p2align 3
L_ATT_LOOP:
    s_waitcnt lgkmcnt(2)
    v_mfma_f32_32x32x16_bf16 v[128:143], v[192:195], v[32:35], v[160:175]
    ds_read_b128 v[216:219], v16 offset:49152
    v_exp_f32 v224, v144
    v_exp_f32_e64 v225, v145
    v_mfma_f32_32x32x16_bf16 v[128:143], v[196:199], v[36:39], v[128:143]
    ds_read_b128 v[220:223], v17 offset:49152
    v_exp_f32 v226, v146
    v_add_f32 v28, v224, v225
    v_exp_f32_e64 v227, v147
    v_mfma_f32_32x32x16_bf16 v[128:143], v[200:203], v[40:43], v[128:143]
    ds_read_b64_tr_b16 v[192:193], v18 offset:0
    ds_read_b64_tr_b16 v[194:195], v18 offset:2048
    v_cvt_pk_bf16_f32 v184, v224, v225
    v_exp_f32_e64 v224, v148
    v_mfma_f32_32x32x16_bf16 v[128:143], v[204:207], v[44:47], v[128:143]
    ds_read_b64_tr_b16 v[196:197], v19 offset:0
    ds_read_b64_tr_b16 v[198:199], v19 offset:2048
    v_add_f32 v29, v226, v227
    v_exp_f32_e64 v225, v149
    s_waitcnt lgkmcnt(4)
    v_mfma_f32_32x32x16_bf16 v[128:143], v[208:211], v[48:51], v[128:143]
    ds_read_b64_tr_b16 v[200:201], v20 offset:0
    ds_read_b64_tr_b16 v[202:203], v20 offset:2048
    v_cvt_pk_bf16_f32 v185, v226, v227
    v_exp_f32_e64 v226, v150
    v_mfma_f32_32x32x16_bf16 v[128:143], v[212:215], v[52:55], v[128:143]
    ds_read_b64_tr_b16 v[204:205], v21 offset:0
    ds_read_b64_tr_b16 v[206:207], v21 offset:2048
    v_add_f32 v28, v28, v224
    v_add_f32 v29, v29, v225
    v_exp_f32_e64 v227, v151
    v_mfma_f32_32x32x16_bf16 v[128:143], v[216:219], v[56:59], v[128:143]
    ds_read_b64_tr_b16 v[208:209], v18 offset:4096
    ds_read_b64_tr_b16 v[210:211], v18 offset:6144
    v_cvt_pk_bf16_f32 v186, v224, v225
    v_exp_f32_e64 v224, v152
    v_mfma_f32_32x32x16_bf16 v[128:143], v[220:223], v[60:63], v[128:143]
    ds_read_b64_tr_b16 v[212:213], v19 offset:4096
    ds_read_b64_tr_b16 v[214:215], v19 offset:6144
    v_add_f32 v28, v28, v226
    v_add_f32_e64 v29, v29, v227
    s_waitcnt lgkmcnt(4)
    v_mfma_f32_32x32x16_bf16 v[64:79], v[192:195], v[176:179], v[64:79]
    ds_read_b64_tr_b16 v[216:217], v20 offset:4096
    ds_read_b64_tr_b16 v[218:219], v20 offset:6144
    v_exp_f32_e64 v225, v153
    v_cvt_pk_bf16_f32 v187, v226, v227
    v_mfma_f32_32x32x16_bf16 v[80:95], v[196:199], v[176:179], v[80:95]
    ds_read_b64_tr_b16 v[220:221], v21 offset:4096
    ds_read_b64_tr_b16 v[222:223], v21 offset:6144
    v_exp_f32 v226, v154
    v_add_f32_e64 v28, v28, v224
    s_barrier
    v_mfma_f32_32x32x16_bf16 v[96:111], v[200:203], v[176:179], v[96:111]
    ds_read_b128 v[192:195], v10 offset:57344
    v_add_f32 v29, v29, v225
    v_exp_f32 v227, v155
    v_cvt_pk_bf16_f32 v188, v224, v225
    v_mfma_f32_32x32x16_bf16 v[112:127], v[204:207], v[176:179], v[112:127]
    ds_read_b128 v[196:199], v11 offset:57344
    v_exp_f32 v224, v156
    v_add_f32 v28, v28, v226
    v_add_f32 v29, v29, v227
    v_exp_f32_e64 v225, v157
    s_waitcnt lgkmcnt(2)
    v_mfma_f32_32x32x16_bf16 v[64:79], v[208:211], v[180:183], v[64:79]
    ds_read_b128 v[200:203], v12 offset:57344
    v_cvt_pk_bf16_f32 v189, v226, v227
    v_exp_f32_e64 v226, v158
    v_mfma_f32_32x32x16_bf16 v[80:95], v[212:215], v[180:183], v[80:95]
    ds_read_b128 v[204:207], v13 offset:57344
    v_add_f32 v28, v28, v224
    v_add_f32 v29, v29, v225
    v_exp_f32_e64 v227, v159
    v_cvt_pk_bf16_f32 v190, v224, v225
    v_mfma_f32_32x32x16_bf16 v[96:111], v[216:219], v[180:183], v[96:111]
    ds_read_b128 v[208:211], v14 offset:57344
    v_add_f32 v28, v28, v226
    v_add_f32 v29, v29, v227
    v_cvt_pk_bf16_f32 v191, v226, v227
    v_add_f32 v28, v28, v29
    v_cmp_nge_f32 vcc, s41, v28
    v_mfma_f32_32x32x16_bf16 v[112:127], v[220:223], v[180:183], v[112:127]
    ds_read_b128 v[212:215], v15 offset:57344
    s_cbranch_vccnz L_RARE_L1
L_RARE_L1_BACK:
    v_add_f32_e64 v30, v30, v28
    s_waitcnt lgkmcnt(2)
    v_mfma_f32_32x32x16_bf16 v[144:159], v[192:195], v[32:35], v[160:175]
    ds_read_b128 v[216:219], v16 offset:57344
    v_exp_f32 v224, v128
    v_exp_f32 v225, v129
    v_mfma_f32_32x32x16_bf16 v[144:159], v[196:199], v[36:39], v[144:159]
    ds_read_b128 v[220:223], v17 offset:57344
    v_exp_f32 v226, v130
    v_add_f32 v28, v224, v225
    v_exp_f32_e64 v227, v131
    v_mfma_f32_32x32x16_bf16 v[144:159], v[200:203], v[40:43], v[144:159]
    ds_read_b64_tr_b16 v[192:193], v18 offset:8192
    ds_read_b64_tr_b16 v[194:195], v18 offset:10240
    v_cvt_pk_bf16_f32 v176, v224, v225
    v_exp_f32_e64 v224, v132
    v_mfma_f32_32x32x16_bf16 v[144:159], v[204:207], v[44:47], v[144:159]
    ds_read_b64_tr_b16 v[196:197], v19 offset:8192
    ds_read_b64_tr_b16 v[198:199], v19 offset:10240
    v_add_f32 v29, v226, v227
    v_exp_f32_e64 v225, v133
    s_waitcnt lgkmcnt(4)
    v_mfma_f32_32x32x16_bf16 v[144:159], v[208:211], v[48:51], v[144:159]
    ds_read_b64_tr_b16 v[200:201], v20 offset:8192
    ds_read_b64_tr_b16 v[202:203], v20 offset:10240
    v_cvt_pk_bf16_f32 v177, v226, v227
    v_exp_f32_e64 v226, v134
    v_mfma_f32_32x32x16_bf16 v[144:159], v[212:215], v[52:55], v[144:159]
    ds_read_b64_tr_b16 v[204:205], v21 offset:8192
    ds_read_b64_tr_b16 v[206:207], v21 offset:10240
    v_add_f32 v28, v28, v224
    v_add_f32 v29, v29, v225
    v_exp_f32_e64 v227, v135
    v_mfma_f32_32x32x16_bf16 v[144:159], v[216:219], v[56:59], v[144:159]
    ds_read_b64_tr_b16 v[208:209], v18 offset:12288
    ds_read_b64_tr_b16 v[210:211], v18 offset:14336
    v_cvt_pk_bf16_f32 v178, v224, v225
    v_exp_f32_e64 v224, v136
    v_mfma_f32_32x32x16_bf16 v[144:159], v[220:223], v[60:63], v[144:159]
    ds_read_b64_tr_b16 v[212:213], v19 offset:12288
    ds_read_b64_tr_b16 v[214:215], v19 offset:14336
    v_add_f32 v28, v28, v226
    v_add_f32_e64 v29, v29, v227
    s_waitcnt lgkmcnt(4)
    v_mfma_f32_32x32x16_bf16 v[64:79], v[192:195], v[184:187], v[64:79]
    ds_read_b64_tr_b16 v[216:217], v20 offset:12288
    ds_read_b64_tr_b16 v[218:219], v20 offset:14336
    v_exp_f32_e64 v225, v137
    v_cvt_pk_bf16_f32 v179, v226, v227
    v_mfma_f32_32x32x16_bf16 v[80:95], v[196:199], v[184:187], v[80:95]
    ds_read_b64_tr_b16 v[220:221], v21 offset:12288
    ds_read_b64_tr_b16 v[222:223], v21 offset:14336
    v_exp_f32 v226, v138
    v_add_f32_e64 v28, v28, v224
    s_barrier
    v_mfma_f32_32x32x16_bf16 v[96:111], v[200:203], v[184:187], v[96:111]
    ds_read_b128 v[192:195], v10 offset:0
    v_add_f32 v29, v29, v225
    v_exp_f32 v227, v139
    v_cvt_pk_bf16_f32 v180, v224, v225
    v_mfma_f32_32x32x16_bf16 v[112:127], v[204:207], v[184:187], v[112:127]
    ds_read_b128 v[196:199], v11 offset:0
    v_exp_f32 v224, v140
    v_add_f32 v28, v28, v226
    v_add_f32 v29, v29, v227
    v_exp_f32_e64 v225, v141
    s_waitcnt lgkmcnt(2)
    v_mfma_f32_32x32x16_bf16 v[64:79], v[208:211], v[188:191], v[64:79]
    ds_read_b128 v[200:203], v12 offset:0
    v_cvt_pk_bf16_f32 v181, v226, v227
    v_exp_f32_e64 v226, v142
    v_mfma_f32_32x32x16_bf16 v[80:95], v[212:215], v[188:191], v[80:95]
    ds_read_b128 v[204:207], v13 offset:0
    v_add_f32 v28, v28, v224
    v_add_f32 v29, v29, v225
    v_exp_f32_e64 v227, v143
    v_cvt_pk_bf16_f32 v182, v224, v225
    v_mfma_f32_32x32x16_bf16 v[96:111], v[216:219], v[188:191], v[96:111]
    ds_read_b128 v[208:211], v14 offset:0
    v_add_f32 v28, v28, v226
    v_add_f32 v29, v29, v227
    v_cvt_pk_bf16_f32 v183, v226, v227
    v_add_f32 v28, v28, v29
    v_cmp_nge_f32 vcc, s41, v28
    v_mfma_f32_32x32x16_bf16 v[112:127], v[220:223], v[188:191], v[112:127]
    ds_read_b128 v[212:215], v15 offset:0
    s_cbranch_vccnz L_RARE_L2
L_RARE_L2_BACK:
    v_add_f32_e64 v30, v30, v28
    s_waitcnt lgkmcnt(2)
    v_mfma_f32_32x32x16_bf16 v[128:143], v[192:195], v[32:35], v[160:175]
    ds_read_b128 v[216:219], v16 offset:0
    v_exp_f32 v224, v144
    v_exp_f32 v225, v145
    v_mfma_f32_32x32x16_bf16 v[128:143], v[196:199], v[36:39], v[128:143]
    ds_read_b128 v[220:223], v17 offset:0
    v_exp_f32 v226, v146
    v_add_f32 v28, v224, v225
    v_exp_f32_e64 v227, v147
    v_mfma_f32_32x32x16_bf16 v[128:143], v[200:203], v[40:43], v[128:143]
    ds_read_b64_tr_b16 v[192:193], v18 offset:16384
    ds_read_b64_tr_b16 v[194:195], v18 offset:18432
    v_cvt_pk_bf16_f32 v184, v224, v225
    v_exp_f32_e64 v224, v148
    v_mfma_f32_32x32x16_bf16 v[128:143], v[204:207], v[44:47], v[128:143]
    ds_read_b64_tr_b16 v[196:197], v19 offset:16384
    ds_read_b64_tr_b16 v[198:199], v19 offset:18432
    v_add_f32 v29, v226, v227
    v_exp_f32_e64 v225, v149
    s_waitcnt lgkmcnt(4)
    v_mfma_f32_32x32x16_bf16 v[128:143], v[208:211], v[48:51], v[128:143]
    ds_read_b64_tr_b16 v[200:201], v20 offset:16384
    ds_read_b64_tr_b16 v[202:203], v20 offset:18432
    v_cvt_pk_bf16_f32 v185, v226, v227
    v_exp_f32_e64 v226, v150
    v_mfma_f32_32x32x16_bf16 v[128:143], v[212:215], v[52:55], v[128:143]
    ds_read_b64_tr_b16 v[204:205], v21 offset:16384
    ds_read_b64_tr_b16 v[206:207], v21 offset:18432
    v_add_f32 v28, v28, v224
    v_add_f32 v29, v29, v225
    v_exp_f32_e64 v227, v151
    v_mfma_f32_32x32x16_bf16 v[128:143], v[216:219], v[56:59], v[128:143]
    ds_read_b64_tr_b16 v[208:209], v18 offset:20480
    ds_read_b64_tr_b16 v[210:211], v18 offset:22528
    v_cvt_pk_bf16_f32 v186, v224, v225
    v_exp_f32_e64 v224, v152
    v_mfma_f32_32x32x16_bf16 v[128:143], v[220:223], v[60:63], v[128:143]
    ds_read_b64_tr_b16 v[212:213], v19 offset:20480
    ds_read_b64_tr_b16 v[214:215], v19 offset:22528
    v_add_f32 v28, v28, v226
    v_add_f32_e64 v29, v29, v227
    s_waitcnt lgkmcnt(4)
    v_mfma_f32_32x32x16_bf16 v[64:79], v[192:195], v[176:179], v[64:79]
    ds_read_b64_tr_b16 v[216:217], v20 offset:20480
    ds_read_b64_tr_b16 v[218:219], v20 offset:22528
    v_exp_f32_e64 v225, v153
    v_cvt_pk_bf16_f32 v187, v226, v227
    v_mfma_f32_32x32x16_bf16 v[80:95], v[196:199], v[176:179], v[80:95]
    ds_read_b64_tr_b16 v[220:221], v21 offset:20480
    ds_read_b64_tr_b16 v[222:223], v21 offset:22528
    v_exp_f32 v226, v154
    v_add_f32_e64 v28, v28, v224
    s_barrier
    v_mfma_f32_32x32x16_bf16 v[96:111], v[200:203], v[176:179], v[96:111]
    ds_read_b128 v[192:195], v10 offset:8192
    v_add_f32 v29, v29, v225
    v_exp_f32 v227, v155
    v_cvt_pk_bf16_f32 v188, v224, v225
    v_mfma_f32_32x32x16_bf16 v[112:127], v[204:207], v[176:179], v[112:127]
    ds_read_b128 v[196:199], v11 offset:8192
    v_exp_f32 v224, v156
    v_add_f32 v28, v28, v226
    v_add_f32 v29, v29, v227
    v_exp_f32_e64 v225, v157
    s_waitcnt lgkmcnt(2)
    v_mfma_f32_32x32x16_bf16 v[64:79], v[208:211], v[180:183], v[64:79]
    ds_read_b128 v[200:203], v12 offset:8192
    v_cvt_pk_bf16_f32 v189, v226, v227
    v_exp_f32_e64 v226, v158
    v_mfma_f32_32x32x16_bf16 v[80:95], v[212:215], v[180:183], v[80:95]
    ds_read_b128 v[204:207], v13 offset:8192
    v_add_f32 v28, v28, v224
    v_add_f32 v29, v29, v225
    v_exp_f32_e64 v227, v159
    v_cvt_pk_bf16_f32 v190, v224, v225
    v_mfma_f32_32x32x16_bf16 v[96:111], v[216:219], v[180:183], v[96:111]
    ds_read_b128 v[208:211], v14 offset:8192
    v_add_f32 v28, v28, v226
    v_add_f32 v29, v29, v227
    v_cvt_pk_bf16_f32 v191, v226, v227
    v_add_f32 v28, v28, v29
    v_cmp_nge_f32 vcc, s41, v28
    v_mfma_f32_32x32x16_bf16 v[112:127], v[220:223], v[180:183], v[112:127]
    ds_read_b128 v[212:215], v15 offset:8192
    s_cbranch_vccnz L_RARE_L3
L_RARE_L3_BACK:
    v_add_f32_e64 v30, v30, v28
    s_waitcnt lgkmcnt(2)
    v_mfma_f32_32x32x16_bf16 v[144:159], v[192:195], v[32:35], v[160:175]
    ds_read_b128 v[216:219], v16 offset:8192
    v_exp_f32 v224, v128
    v_exp_f32 v225, v129
    v_mfma_f32_32x32x16_bf16 v[144:159], v[196:199], v[36:39], v[144:159]
    ds_read_b128 v[220:223], v17 offset:8192
    v_exp_f32 v226, v130
    v_add_f32 v28, v224, v225
    v_exp_f32_e64 v227, v131
    v_mfma_f32_32x32x16_bf16 v[144:159], v[200:203], v[40:43], v[144:159]
    ds_read_b64_tr_b16 v[192:193], v18 offset:24576
    ds_read_b64_tr_b16 v[194:195], v18 offset:26624
    v_cvt_pk_bf16_f32 v176, v224, v225
    v_exp_f32_e64 v224, v132
    v_mfma_f32_32x32x16_bf16 v[144:159], v[204:207], v[44:47], v[144:159]
    ds_read_b64_tr_b16 v[196:197], v19 offset:24576
    ds_read_b64_tr_b16 v[198:199], v19 offset:26624
    v_add_f32 v29, v226, v227
    v_exp_f32_e64 v225, v133
    s_waitcnt lgkmcnt(4)
    v_mfma_f32_32x32x16_bf16 v[144:159], v[208:211], v[48:51], v[144:159]
    ds_read_b64_tr_b16 v[200:201], v20 offset:24576
    ds_read_b64_tr_b16 v[202:203], v20 offset:26624
    v_cvt_pk_bf16_f32 v177, v226, v227
    v_exp_f32_e64 v226, v134
    v_mfma_f32_32x32x16_bf16 v[144:159], v[212:215], v[52:55], v[144:159]
    ds_read_b64_tr_b16 v[204:205], v21 offset:24576
    ds_read_b64_tr_b16 v[206:207], v21 offset:26624
    v_add_f32 v28, v28, v224
    v_add_f32 v29, v29, v225
    v_exp_f32_e64 v227, v135
    v_mfma_f32_32x32x16_bf16 v[144:159], v[216:219], v[56:59], v[144:159]
    ds_read_b64_tr_b16 v[208:209], v18 offset:28672
    ds_read_b64_tr_b16 v[210:211], v18 offset:30720
    v_cvt_pk_bf16_f32 v178, v224, v225
    v_exp_f32_e64 v224, v136
    v_mfma_f32_32x32x16_bf16 v[144:159], v[220:223], v[60:63], v[144:159]
    ds_read_b64_tr_b16 v[212:213], v19 offset:28672
    ds_read_b64_tr_b16 v[214:215], v19 offset:30720
    v_add_f32 v28, v28, v226
    v_add_f32_e64 v29, v29, v227
    s_waitcnt lgkmcnt(4)
    v_mfma_f32_32x32x16_bf16 v[64:79], v[192:195], v[184:187], v[64:79]
    ds_read_b64_tr_b16 v[216:217], v20 offset:28672
    ds_read_b64_tr_b16 v[218:219], v20 offset:30720
    v_exp_f32_e64 v225, v137
    v_cvt_pk_bf16_f32 v179, v226, v227
    v_mfma_f32_32x32x16_bf16 v[80:95], v[196:199], v[184:187], v[80:95]
    ds_read_b64_tr_b16 v[220:221], v21 offset:28672
    ds_read_b64_tr_b16 v[222:223], v21 offset:30720
    v_exp_f32 v226, v138
    v_add_f32_e64 v28, v28, v224
    s_barrier
    v_mfma_f32_32x32x16_bf16 v[96:111], v[200:203], v[184:187], v[96:111]
    ds_read_b128 v[192:195], v10 offset:16384
    v_add_f32 v29, v29, v225
    v_exp_f32 v227, v139
    v_cvt_pk_bf16_f32 v180, v224, v225
    v_mfma_f32_32x32x16_bf16 v[112:127], v[204:207], v[184:187], v[112:127]
    ds_read_b128 v[196:199], v11 offset:16384
    v_exp_f32 v224, v140
    v_add_f32 v28, v28, v226
    v_add_f32 v29, v29, v227
    v_exp_f32_e64 v225, v141
    s_waitcnt lgkmcnt(2)
    v_mfma_f32_32x32x16_bf16 v[64:79], v[208:211], v[188:191], v[64:79]
    ds_read_b128 v[200:203], v12 offset:16384
    v_cvt_pk_bf16_f32 v181, v226, v227
    v_exp_f32_e64 v226, v142
    v_mfma_f32_32x32x16_bf16 v[80:95], v[212:215], v[188:191], v[80:95]
    ds_read_b128 v[204:207], v13 offset:16384
    v_add_f32 v28, v28, v224
    v_add_f32 v29, v29, v225
    v_exp_f32_e64 v227, v143
    v_cvt_pk_bf16_f32 v182, v224, v225
    v_mfma_f32_32x32x16_bf16 v[96:111], v[216:219], v[188:191], v[96:111]
    ds_read_b128 v[208:211], v14 offset:16384
    v_add_f32 v28, v28, v226
    v_add_f32 v29, v29, v227
    v_cvt_pk_bf16_f32 v183, v226, v227
    v_add_f32 v28, v28, v29
    v_cmp_nge_f32 vcc, s41, v28
    v_mfma_f32_32x32x16_bf16 v[112:127], v[220:223], v[188:191], v[112:127]
    ds_read_b128 v[212:215], v15 offset:16384
    s_cbranch_vccnz L_RARE_L4
L_RARE_L4_BACK:
    v_add_f32_e64 v30, v30, v28
    s_waitcnt lgkmcnt(2)
    v_mfma_f32_32x32x16_bf16 v[128:143], v[192:195], v[32:35], v[160:175]
    ds_read_b128 v[216:219], v16 offset:16384
    v_exp_f32 v224, v144
    v_exp_f32 v225, v145
    v_mfma_f32_32x32x16_bf16 v[128:143], v[196:199], v[36:39], v[128:143]
    ds_read_b128 v[220:223], v17 offset:16384
    v_exp_f32 v226, v146
    v_add_f32 v28, v224, v225
    v_exp_f32_e64 v227, v147
    v_mfma_f32_32x32x16_bf16 v[128:143], v[200:203], v[40:43], v[128:143]
    ds_read_b64_tr_b16 v[192:193], v18 offset:32768
    ds_read_b64_tr_b16 v[194:195], v18 offset:34816
    v_cvt_pk_bf16_f32 v184, v224, v225
    v_exp_f32_e64 v224, v148
    v_mfma_f32_32x32x16_bf16 v[128:143], v[204:207], v[44:47], v[128:143]
    ds_read_b64_tr_b16 v[196:197], v19 offset:32768
    ds_read_b64_tr_b16 v[198:199], v19 offset:34816
    v_add_f32 v29, v226, v227
    v_exp_f32_e64 v225, v149
    s_waitcnt lgkmcnt(4)
    v_mfma_f32_32x32x16_bf16 v[128:143], v[208:211], v[48:51], v[128:143]
    ds_read_b64_tr_b16 v[200:201], v20 offset:32768
    ds_read_b64_tr_b16 v[202:203], v20 offset:34816
    v_cvt_pk_bf16_f32 v185, v226, v227
    v_exp_f32_e64 v226, v150
    v_mfma_f32_32x32x16_bf16 v[128:143], v[212:215], v[52:55], v[128:143]
    ds_read_b64_tr_b16 v[204:205], v21 offset:32768
    ds_read_b64_tr_b16 v[206:207], v21 offset:34816
    v_add_f32 v28, v28, v224
    v_add_f32 v29, v29, v225
    v_exp_f32_e64 v227, v151
    v_mfma_f32_32x32x16_bf16 v[128:143], v[216:219], v[56:59], v[128:143]
    ds_read_b64_tr_b16 v[208:209], v18 offset:36864
    ds_read_b64_tr_b16 v[210:211], v18 offset:38912
    v_cvt_pk_bf16_f32 v186, v224, v225
    v_exp_f32_e64 v224, v152
    v_mfma_f32_32x32x16_bf16 v[128:143], v[220:223], v[60:63], v[128:143]
    ds_read_b64_tr_b16 v[212:213], v19 offset:36864
    ds_read_b64_tr_b16 v[214:215], v19 offset:38912
    v_add_f32 v28, v28, v226
    v_add_f32_e64 v29, v29, v227
    s_waitcnt lgkmcnt(4)
    v_mfma_f32_32x32x16_bf16 v[64:79], v[192:195], v[176:179], v[64:79]
    ds_read_b64_tr_b16 v[216:217], v20 offset:36864
    ds_read_b64_tr_b16 v[218:219], v20 offset:38912
    v_exp_f32_e64 v225, v153
    v_cvt_pk_bf16_f32 v187, v226, v227
    v_mfma_f32_32x32x16_bf16 v[80:95], v[196:199], v[176:179], v[80:95]
    ds_read_b64_tr_b16 v[220:221], v21 offset:36864
    ds_read_b64_tr_b16 v[222:223], v21 offset:38912
    v_exp_f32 v226, v154
    v_add_f32_e64 v28, v28, v224
    s_barrier
    v_mfma_f32_32x32x16_bf16 v[96:111], v[200:203], v[176:179], v[96:111]
    ds_read_b128 v[192:195], v10 offset:24576
    v_add_f32 v29, v29, v225
    v_exp_f32 v227, v155
    v_cvt_pk_bf16_f32 v188, v224, v225
    v_mfma_f32_32x32x16_bf16 v[112:127], v[204:207], v[176:179], v[112:127]
    ds_read_b128 v[196:199], v11 offset:24576
    v_exp_f32 v224, v156
    v_add_f32 v28, v28, v226
    v_add_f32 v29, v29, v227
    v_exp_f32_e64 v225, v157
    s_waitcnt lgkmcnt(2)
    v_mfma_f32_32x32x16_bf16 v[64:79], v[208:211], v[180:183], v[64:79]
    ds_read_b128 v[200:203], v12 offset:24576
    v_cvt_pk_bf16_f32 v189, v226, v227
    v_exp_f32_e64 v226, v158
    v_mfma_f32_32x32x16_bf16 v[80:95], v[212:215], v[180:183], v[80:95]
    ds_read_b128 v[204:207], v13 offset:24576
    v_add_f32 v28, v28, v224
    v_add_f32 v29, v29, v225
    v_exp_f32_e64 v227, v159
    v_cvt_pk_bf16_f32 v190, v224, v225
    v_mfma_f32_32x32x16_bf16 v[96:111], v[216:219], v[180:183], v[96:111]
    ds_read_b128 v[208:211], v14 offset:24576
    v_add_f32 v28, v28, v226
    v_add_f32 v29, v29, v227
    v_cvt_pk_bf16_f32 v191, v226, v227
    v_add_f32 v28, v28, v29
    v_cmp_nge_f32 vcc, s41, v28
    v_mfma_f32_32x32x16_bf16 v[112:127], v[220:223], v[180:183], v[112:127]
    ds_read_b128 v[212:215], v15 offset:24576
    s_cbranch_vccnz L_RARE_L5
L_RARE_L5_BACK:
    v_add_f32_e64 v30, v30, v28
    s_waitcnt lgkmcnt(2)
    v_mfma_f32_32x32x16_bf16 v[144:159], v[192:195], v[32:35], v[160:175]
    ds_read_b128 v[216:219], v16 offset:24576
    v_exp_f32 v224, v128
    v_exp_f32 v225, v129
    v_mfma_f32_32x32x16_bf16 v[144:159], v[196:199], v[36:39], v[144:159]
    ds_read_b128 v[220:223], v17 offset:24576
    v_exp_f32 v226, v130
    v_add_f32 v28, v224, v225
    v_exp_f32_e64 v227, v131
    v_mfma_f32_32x32x16_bf16 v[144:159], v[200:203], v[40:43], v[144:159]
    ds_read_b64_tr_b16 v[192:193], v18 offset:40960
    ds_read_b64_tr_b16 v[194:195], v18 offset:43008
    v_cvt_pk_bf16_f32 v176, v224, v225
    v_exp_f32_e64 v224, v132
    v_mfma_f32_32x32x16_bf16 v[144:159], v[204:207], v[44:47], v[144:159]
    ds_read_b64_tr_b16 v[196:197], v19 offset:40960
    ds_read_b64_tr_b16 v[198:199], v19 offset:43008
    v_add_f32 v29, v226, v227
    v_exp_f32_e64 v225, v133
    s_waitcnt lgkmcnt(4)
    v_mfma_f32_32x32x16_bf16 v[144:159], v[208:211], v[48:51], v[144:159]
    ds_read_b64_tr_b16 v[200:201], v20 offset:40960
    ds_read_b64_tr_b16 v[202:203], v20 offset:43008
    v_cvt_pk_bf16_f32 v177, v226, v227
    v_exp_f32_e64 v226, v134
    v_mfma_f32_32x32x16_bf16 v[144:159], v[212:215], v[52:55], v[144:159]
    ds_read_b64_tr_b16 v[204:205], v21 offset:40960
    ds_read_b64_tr_b16 v[206:207], v21 offset:43008
    v_add_f32 v28, v28, v224
    v_add_f32 v29, v29, v225
    v_exp_f32_e64 v227, v135
    v_mfma_f32_32x32x16_bf16 v[144:159], v[216:219], v[56:59], v[144:159]
    ds_read_b64_tr_b16 v[208:209], v18 offset:45056
    ds_read_b64_tr_b16 v[210:211], v18 offset:47104
    v_cvt_pk_bf16_f32 v178, v224, v225
    v_exp_f32_e64 v224, v136
    v_mfma_f32_32x32x16_bf16 v[144:159], v[220:223], v[60:63], v[144:159]
    ds_read_b64_tr_b16 v[212:213], v19 offset:45056
    ds_read_b64_tr_b16 v[214:215], v19 offset:47104
    v_add_f32 v28, v28, v226
    v_add_f32_e64 v29, v29, v227
    s_waitcnt lgkmcnt(4)
    v_mfma_f32_32x32x16_bf16 v[64:79], v[192:195], v[184:187], v[64:79]
    ds_read_b64_tr_b16 v[216:217], v20 offset:45056
    ds_read_b64_tr_b16 v[218:219], v20 offset:47104
    v_exp_f32_e64 v225, v137
    v_cvt_pk_bf16_f32 v179, v226, v227
    v_mfma_f32_32x32x16_bf16 v[80:95], v[196:199], v[184:187], v[80:95]
    ds_read_b64_tr_b16 v[220:221], v21 offset:45056
    ds_read_b64_tr_b16 v[222:223], v21 offset:47104
    v_exp_f32 v226, v138
    v_add_f32_e64 v28, v28, v224
    s_barrier
    v_mfma_f32_32x32x16_bf16 v[96:111], v[200:203], v[184:187], v[96:111]
    ds_read_b128 v[192:195], v10 offset:32768
    v_add_f32 v29, v29, v225
    v_exp_f32 v227, v139
    v_cvt_pk_bf16_f32 v180, v224, v225
    v_mfma_f32_32x32x16_bf16 v[112:127], v[204:207], v[184:187], v[112:127]
    ds_read_b128 v[196:199], v11 offset:32768
    v_exp_f32 v224, v140
    v_add_f32 v28, v28, v226
    v_add_f32 v29, v29, v227
    v_exp_f32_e64 v225, v141
    s_waitcnt lgkmcnt(2)
    v_mfma_f32_32x32x16_bf16 v[64:79], v[208:211], v[188:191], v[64:79]
    ds_read_b128 v[200:203], v12 offset:32768
    v_cvt_pk_bf16_f32 v181, v226, v227
    v_exp_f32_e64 v226, v142
    v_mfma_f32_32x32x16_bf16 v[80:95], v[212:215], v[188:191], v[80:95]
    ds_read_b128 v[204:207], v13 offset:32768
    v_add_f32 v28, v28, v224
    v_add_f32 v29, v29, v225
    v_exp_f32_e64 v227, v143
    v_cvt_pk_bf16_f32 v182, v224, v225
    v_mfma_f32_32x32x16_bf16 v[96:111], v[216:219], v[188:191], v[96:111]
    ds_read_b128 v[208:211], v14 offset:32768
    v_add_f32 v28, v28, v226
    v_add_f32 v29, v29, v227
    v_cvt_pk_bf16_f32 v183, v226, v227
    v_add_f32 v28, v28, v29
    v_cmp_nge_f32 vcc, s41, v28
    v_mfma_f32_32x32x16_bf16 v[112:127], v[220:223], v[188:191], v[112:127]
    ds_read_b128 v[212:215], v15 offset:32768
    s_cbranch_vccnz L_RARE_L6
L_RARE_L6_BACK:
    v_add_f32_e64 v30, v30, v28
    s_cmp_eq_u32 s40, 3
    s_cbranch_scc1 L_ATT_EXIT
    s_waitcnt lgkmcnt(2)
    v_mfma_f32_32x32x16_bf16 v[128:143], v[192:195], v[32:35], v[160:175]
    ds_read_b128 v[216:219], v16 offset:32768
    v_exp_f32 v224, v144
    v_exp_f32 v225, v145
    v_mfma_f32_32x32x16_bf16 v[128:143], v[196:199], v[36:39], v[128:143]
    ds_read_b128 v[220:223], v17 offset:32768
    v_exp_f32 v226, v146
    v_add_f32 v28, v224, v225
    v_exp_f32_e64 v227, v147
    v_mfma_f32_32x32x16_bf16 v[128:143], v[200:203], v[40:43], v[128:143]
    ds_read_b64_tr_b16 v[192:193], v18 offset:49152
    ds_read_b64_tr_b16 v[194:195], v18 offset:51200
    v_cvt_pk_bf16_f32 v184, v224, v225
    v_exp_f32_e64 v224, v148
    v_mfma_f32_32x32x16_bf16 v[128:143], v[204:207], v[44:47], v[128:143]
    ds_read_b64_tr_b16 v[196:197], v19 offset:49152
    ds_read_b64_tr_b16 v[198:199], v19 offset:51200
    v_add_f32 v29, v226, v227
    v_exp_f32_e64 v225, v149
    s_waitcnt lgkmcnt(4)
    v_mfma_f32_32x32x16_bf16 v[128:143], v[208:211], v[48:51], v[128:143]
    ds_read_b64_tr_b16 v[200:201], v20 offset:49152
    ds_read_b64_tr_b16 v[202:203], v20 offset:51200
    v_cvt_pk_bf16_f32 v185, v226, v227
    v_exp_f32_e64 v226, v150
    v_mfma_f32_32x32x16_bf16 v[128:143], v[212:215], v[52:55], v[128:143]
    ds_read_b64_tr_b16 v[204:205], v21 offset:49152
    ds_read_b64_tr_b16 v[206:207], v21 offset:51200
    v_add_f32 v28, v28, v224
    v_add_f32 v29, v29, v225
    v_exp_f32_e64 v227, v151
    v_mfma_f32_32x32x16_bf16 v[128:143], v[216:219], v[56:59], v[128:143]
    ds_read_b64_tr_b16 v[208:209], v18 offset:53248
    ds_read_b64_tr_b16 v[210:211], v18 offset:55296
    v_cvt_pk_bf16_f32 v186, v224, v225
    v_exp_f32_e64 v224, v152
    v_mfma_f32_32x32x16_bf16 v[128:143], v[220:223], v[60:63], v[128:143]
    ds_read_b64_tr_b16 v[212:213], v19 offset:53248
    ds_read_b64_tr_b16 v[214:215], v19 offset:55296
    v_add_f32 v28, v28, v226
    v_add_f32_e64 v29, v29, v227
    s_waitcnt lgkmcnt(4)
    v_mfma_f32_32x32x16_bf16 v[64:79], v[192:195], v[176:179], v[64:79]
    ds_read_b64_tr_b16 v[216:217], v20 offset:53248
    ds_read_b64_tr_b16 v[218:219], v20 offset:55296
    v_exp_f32_e64 v225, v153
    v_cvt_pk_bf16_f32 v187, v226, v227
    v_mfma_f32_32x32x16_bf16 v[80:95], v[196:199], v[176:179], v[80:95]
    ds_read_b64_tr_b16 v[220:221], v21 offset:53248
    ds_read_b64_tr_b16 v[222:223], v21 offset:55296
    v_exp_f32 v226, v154
    v_add_f32_e64 v28, v28, v224
    s_barrier
    v_mfma_f32_32x32x16_bf16 v[96:111], v[200:203], v[176:179], v[96:111]
    ds_read_b128 v[192:195], v10 offset:40960
    v_add_f32 v29, v29, v225
    v_exp_f32 v227, v155
    v_cvt_pk_bf16_f32 v188, v224, v225
    v_mfma_f32_32x32x16_bf16 v[112:127], v[204:207], v[176:179], v[112:127]
    ds_read_b128 v[196:199], v11 offset:40960
    v_exp_f32 v224, v156
    v_add_f32 v28, v28, v226
    v_add_f32 v29, v29, v227
    v_exp_f32_e64 v225, v157
    s_waitcnt lgkmcnt(2)
    v_mfma_f32_32x32x16_bf16 v[64:79], v[208:211], v[180:183], v[64:79]
    ds_read_b128 v[200:203], v12 offset:40960
    v_cvt_pk_bf16_f32 v189, v226, v227
    v_exp_f32_e64 v226, v158
    v_mfma_f32_32x32x16_bf16 v[80:95], v[212:215], v[180:183], v[80:95]
    ds_read_b128 v[204:207], v13 offset:40960
    v_add_f32 v28, v28, v224
    v_add_f32 v29, v29, v225
    v_exp_f32_e64 v227, v159
    v_cvt_pk_bf16_f32 v190, v224, v225
    v_mfma_f32_32x32x16_bf16 v[96:111], v[216:219], v[180:183], v[96:111]
    ds_read_b128 v[208:211], v14 offset:40960
    v_add_f32 v28, v28, v226
    v_add_f32 v29, v29, v227
    v_cvt_pk_bf16_f32 v191, v226, v227
    v_add_f32 v28, v28, v29
    v_cmp_nge_f32 vcc, s41, v28
    v_mfma_f32_32x32x16_bf16 v[112:127], v[220:223], v[180:183], v[112:127]
    ds_read_b128 v[212:215], v15 offset:40960
    s_cbranch_vccnz L_RARE_L7
L_RARE_L7_BACK:
    v_add_f32_e64 v30, v30, v28
    s_waitcnt lgkmcnt(2)
    v_mfma_f32_32x32x16_bf16 v[144:159], v[192:195], v[32:35], v[160:175]
    ds_read_b128 v[216:219], v16 offset:40960
    v_exp_f32 v224, v128
    v_exp_f32 v225, v129
    v_mfma_f32_32x32x16_bf16 v[144:159], v[196:199], v[36:39], v[144:159]
    ds_read_b128 v[220:223], v17 offset:40960
    v_exp_f32 v226, v130
    v_add_f32 v28, v224, v225
    v_exp_f32_e64 v227, v131
    v_mfma_f32_32x32x16_bf16 v[144:159], v[200:203], v[40:43], v[144:159]
    ds_read_b64_tr_b16 v[192:193], v18 offset:57344
    ds_read_b64_tr_b16 v[194:195], v18 offset:59392
    v_cvt_pk_bf16_f32 v176, v224, v225
    v_exp_f32_e64 v224, v132
    v_mfma_f32_32x32x16_bf16 v[144:159], v[204:207], v[44:47], v[144:159]
    ds_read_b64_tr_b16 v[196:197], v19 offset:57344
    ds_read_b64_tr_b16 v[198:199], v19 offset:59392
    v_add_f32 v29, v226, v227
    v_exp_f32_e64 v225, v133
    s_waitcnt lgkmcnt(4)
    v_mfma_f32_32x32x16_bf16 v[144:159], v[208:211], v[48:51], v[144:159]
    ds_read_b64_tr_b16 v[200:201], v20 offset:57344
    ds_read_b64_tr_b16 v[202:203], v20 offset:59392
    v_cvt_pk_bf16_f32 v177, v226, v227
    v_exp_f32_e64 v226, v134
    v_mfma_f32_32x32x16_bf16 v[144:159], v[212:215], v[52:55], v[144:159]
    ds_read_b64_tr_b16 v[204:205], v21 offset:57344
    ds_read_b64_tr_b16 v[206:207], v21 offset:59392
    v_add_f32 v28, v28, v224
    v_add_f32 v29, v29, v225
    v_exp_f32_e64 v227, v135
    v_mfma_f32_32x32x16_bf16 v[144:159], v[216:219], v[56:59], v[144:159]
    ds_read_b64_tr_b16 v[208:209], v18 offset:61440
    ds_read_b64_tr_b16 v[210:211], v18 offset:63488
    v_cvt_pk_bf16_f32 v178, v224, v225
    v_exp_f32_e64 v224, v136
    v_mfma_f32_32x32x16_bf16 v[144:159], v[220:223], v[60:63], v[144:159]
    ds_read_b64_tr_b16 v[212:213], v19 offset:61440
    ds_read_b64_tr_b16 v[214:215], v19 offset:63488
    v_add_f32 v28, v28, v226
    v_add_f32_e64 v29, v29, v227
    s_waitcnt lgkmcnt(4)
    v_mfma_f32_32x32x16_bf16 v[64:79], v[192:195], v[184:187], v[64:79]
    ds_read_b64_tr_b16 v[216:217], v20 offset:61440
    ds_read_b64_tr_b16 v[218:219], v20 offset:63488
    v_exp_f32_e64 v225, v137
    v_cvt_pk_bf16_f32 v179, v226, v227
    v_mfma_f32_32x32x16_bf16 v[80:95], v[196:199], v[184:187], v[80:95]
    ds_read_b64_tr_b16 v[220:221], v21 offset:61440
    ds_read_b64_tr_b16 v[222:223], v21 offset:63488
    v_exp_f32 v226, v138
    v_add_f32_e64 v28, v28, v224
    s_barrier
    v_mfma_f32_32x32x16_bf16 v[96:111], v[200:203], v[184:187], v[96:111]
    ds_read_b128 v[192:195], v10 offset:49152
    v_add_f32 v29, v29, v225
    v_exp_f32 v227, v139
    v_cvt_pk_bf16_f32 v180, v224, v225
    v_mfma_f32_32x32x16_bf16 v[112:127], v[204:207], v[184:187], v[112:127]
    ds_read_b128 v[196:199], v11 offset:49152
    v_exp_f32 v224, v140
    v_add_f32 v28, v28, v226
    v_add_f32 v29, v29, v227
    v_exp_f32_e64 v225, v141
    s_waitcnt lgkmcnt(2)
    v_mfma_f32_32x32x16_bf16 v[64:79], v[208:211], v[188:191], v[64:79]
    ds_read_b128 v[200:203], v12 offset:49152
    v_cvt_pk_bf16_f32 v181, v226, v227
    v_exp_f32_e64 v226, v142
    v_mfma_f32_32x32x16_bf16 v[80:95], v[212:215], v[188:191], v[80:95]
    ds_read_b128 v[204:207], v13 offset:49152
    v_add_f32 v28, v28, v224
    v_add_f32 v29, v29, v225
    v_exp_f32_e64 v227, v143
    v_cvt_pk_bf16_f32 v182, v224, v225
    v_mfma_f32_32x32x16_bf16 v[96:111], v[216:219], v[188:191], v[96:111]
    ds_read_b128 v[208:211], v14 offset:49152
    v_add_f32 v28, v28, v226
    v_add_f32 v29, v29, v227
    v_cvt_pk_bf16_f32 v183, v226, v227
    v_add_f32 v28, v28, v29
    v_cmp_nge_f32 vcc, s41, v28
    v_mfma_f32_32x32x16_bf16 v[112:127], v[220:223], v[188:191], v[112:127]
    ds_read_b128 v[212:215], v15 offset:49152
    s_cbranch_vccnz L_RARE_L8
L_RARE_L8_BACK:
    v_add_f32 v30, v30, v28
    s_add_u32 s40, s40, 1
    s_branch L_ATT_LOOP
L_ATT_EXIT:
    v_exp_f32 v224, v144
    v_exp_f32 v225, v145
    v_exp_f32 v226, v146
    v_add_f32 v28, v224, v225
    v_exp_f32_e64 v227, v147
    v_cvt_pk_bf16_f32 v184, v224, v225
    v_exp_f32 v224, v148
    v_add_f32 v29, v226, v227
    ds_read_b64_tr_b16 v[192:193], v18 offset:49152
    ds_read_b64_tr_b16 v[194:195], v18 offset:51200
    v_exp_f32_e64 v225, v149
    v_cvt_pk_bf16_f32 v185, v226, v227
    ds_read_b64_tr_b16 v[196:197], v19 offset:49152
    ds_read_b64_tr_b16 v[198:199], v19 offset:51200
    v_exp_f32 v226, v150
    v_add_f32 v28, v28, v224
    v_add_f32_e64 v29, v29, v225
    ds_read_b64_tr_b16 v[200:201], v20 offset:49152
    ds_read_b64_tr_b16 v[202:203], v20 offset:51200
    v_exp_f32_e64 v227, v151
    v_cvt_pk_bf16_f32 v186, v224, v225
    ds_read_b64_tr_b16 v[204:205], v21 offset:49152
    ds_read_b64_tr_b16 v[206:207], v21 offset:51200
    v_exp_f32 v224, v152
    v_add_f32 v28, v28, v226
    v_add_f32_e64 v29, v29, v227
    ds_read_b64_tr_b16 v[208:209], v18 offset:53248
    ds_read_b64_tr_b16 v[210:211], v18 offset:55296
    v_exp_f32_e64 v225, v153
    v_cvt_pk_bf16_f32 v187, v226, v227
    ds_read_b64_tr_b16 v[212:213], v19 offset:53248
    ds_read_b64_tr_b16 v[214:215], v19 offset:55296
    v_exp_f32 v226, v154
    v_add_f32 v28, v28, v224
    v_add_f32 v29, v29, v225
    s_waitcnt lgkmcnt(4)
    v_mfma_f32_32x32x16_bf16 v[64:79], v[192:195], v[176:179], v[64:79]
    ds_read_b64_tr_b16 v[216:217], v20 offset:53248
    ds_read_b64_tr_b16 v[218:219], v20 offset:55296
    v_exp_f32_e64 v227, v155
    v_mfma_f32_32x32x16_bf16 v[80:95], v[196:199], v[176:179], v[80:95]
    ds_read_b64_tr_b16 v[220:221], v21 offset:53248
    ds_read_b64_tr_b16 v[222:223], v21 offset:55296
    v_cvt_pk_bf16_f32 v188, v224, v225
    v_exp_f32 v224, v156
    v_add_f32_e64 v28, v28, v226
    s_barrier
    v_mfma_f32_32x32x16_bf16 v[96:111], v[200:203], v[176:179], v[96:111]
    ds_read_b64_tr_b16 v[192:193], v18 offset:57344
    ds_read_b64_tr_b16 v[194:195], v18 offset:59392
    v_add_f32 v29, v29, v227
    v_exp_f32 v225, v157
    v_mfma_f32_32x32x16_bf16 v[112:127], v[204:207], v[176:179], v[112:127]
    ds_read_b64_tr_b16 v[196:197], v19 offset:57344
    ds_read_b64_tr_b16 v[198:199], v19 offset:59392
    v_cvt_pk_bf16_f32 v189, v226, v227
    v_exp_f32 v226, v158
    s_waitcnt lgkmcnt(4)
    v_mfma_f32_32x32x16_bf16 v[64:79], v[208:211], v[180:183], v[64:79]
    ds_read_b64_tr_b16 v[200:201], v20 offset:57344
    ds_read_b64_tr_b16 v[202:203], v20 offset:59392
    v_add_f32 v28, v28, v224
    v_add_f32 v29, v29, v225
    v_mfma_f32_32x32x16_bf16 v[80:95], v[212:215], v[180:183], v[80:95]
    ds_read_b64_tr_b16 v[204:205], v21 offset:57344
    ds_read_b64_tr_b16 v[206:207], v21 offset:59392
    v_exp_f32_e64 v227, v159
    v_cvt_pk_bf16_f32 v190, v224, v225
    v_add_f32_e64 v28, v28, v226
    v_mfma_f32_32x32x16_bf16 v[96:111], v[216:219], v[180:183], v[96:111]
    ds_read_b64_tr_b16 v[208:209], v18 offset:61440
    ds_read_b64_tr_b16 v[210:211], v18 offset:63488
    v_add_f32_e64 v29, v29, v227
    v_cvt_pk_bf16_f32 v191, v226, v227
    v_add_f32 v28, v28, v29
    v_cmp_nge_f32 vcc, s41, v28
    v_mfma_f32_32x32x16_bf16 v[112:127], v[220:223], v[180:183], v[112:127]
    ds_read_b64_tr_b16 v[212:213], v19 offset:61440
    ds_read_b64_tr_b16 v[214:215], v19 offset:63488
    s_cbranch_vccnz L_RARE_31
L_RARE_31_BACK:
    v_add_f32_e64 v30, v30, v28
    s_waitcnt lgkmcnt(4)
    v_mfma_f32_32x32x16_bf16 v[64:79], v[192:195], v[184:187], v[64:79]
    ds_read_b64_tr_b16 v[216:217], v20 offset:61440
    ds_read_b64_tr_b16 v[218:219], v20 offset:63488
    v_mfma_f32_32x32x16_bf16 v[80:95], v[196:199], v[184:187], v[80:95]
    ds_read_b64_tr_b16 v[220:221], v21 offset:61440
    ds_read_b64_tr_b16 v[222:223], v21 offset:63488
    v_mfma_f32_32x32x16_bf16 v[96:111], v[200:203], v[184:187], v[96:111]
    v_mov_b32 v31, v30
    s_nop 1
    v_permlane32_swap_b32 v30, v31
    s_nop 1
    v_add_f32 v30, v30, v31
    v_rcp_f32 v30, v30
    v_mfma_f32_32x32x16_bf16 v[112:127], v[204:207], v[184:187], v[112:127]
    s_waitcnt lgkmcnt(0)
    v_mfma_f32_32x32x16_bf16 v[64:79], v[208:211], v[188:191], v[64:79]
    v_mfma_f32_32x32x16_bf16 v[80:95], v[212:215], v[188:191], v[80:95]
    v_mfma_f32_32x32x16_bf16 v[96:111], v[216:219], v[188:191], v[96:111]
    v_mfma_f32_32x32x16_bf16 v[112:127], v[220:223], v[188:191], v[112:127]
    s_barrier
    v_add_u32 v245, 0x8000, v244
    v_xor_b32_e64 v246, 32, v245
    ds_read_b64_tr_b16 v[128:129], v245 offset:0
    ds_read_b64_tr_b16 v[130:131], v245 offset:1024
    ds_read_b64_tr_b16 v[132:133], v246 offset:0
    ds_read_b64_tr_b16 v[134:135], v246 offset:1024
    ds_read_b64_tr_b16 v[136:137], v245 offset:8192
    ds_read_b64_tr_b16 v[138:139], v245 offset:9216
    ds_read_b64_tr_b16 v[140:141], v246 offset:8192
    ds_read_b64_tr_b16 v[142:143], v246 offset:9216
    ds_read_b64_tr_b16 v[144:145], v245 offset:16384
    ds_read_b64_tr_b16 v[146:147], v245 offset:17408
    ds_read_b64_tr_b16 v[148:149], v246 offset:16384
    ds_read_b64_tr_b16 v[150:151], v246 offset:17408
    ds_read_b64_tr_b16 v[152:153], v245 offset:24576
    ds_read_b64_tr_b16 v[154:155], v245 offset:25600
    ds_read_b64_tr_b16 v[156:157], v246 offset:24576
    ds_read_b64_tr_b16 v[158:159], v246 offset:25600
    s_nop 7
    v_pk_mul_f32 v[64:65], v[64:65], v[30:31] op_sel_hi:[1,0]
    v_pk_mul_f32 v[66:67], v[66:67], v[30:31] op_sel_hi:[1,0]
    v_cvt_pk_bf16_f32 v64, v64, v65
    v_cvt_pk_bf16_f32 v65, v66, v67
    ds_write_b64 v237, v[64:65] offset:0
    v_pk_mul_f32 v[68:69], v[68:69], v[30:31] op_sel_hi:[1,0]
    v_pk_mul_f32 v[70:71], v[70:71], v[30:31] op_sel_hi:[1,0]
    v_cvt_pk_bf16_f32 v68, v68, v69
    v_cvt_pk_bf16_f32 v69, v70, v71
    ds_write_b64 v237, v[68:69] offset:16
    v_pk_mul_f32 v[72:73], v[72:73], v[30:31] op_sel_hi:[1,0]
    v_pk_mul_f32 v[74:75], v[74:75], v[30:31] op_sel_hi:[1,0]
    v_cvt_pk_bf16_f32 v72, v72, v73
    v_cvt_pk_bf16_f32 v73, v74, v75
    ds_write_b64 v237, v[72:73] offset:32
    v_pk_mul_f32 v[76:77], v[76:77], v[30:31] op_sel_hi:[1,0]
    v_pk_mul_f32 v[78:79], v[78:79], v[30:31] op_sel_hi:[1,0]
    v_cvt_pk_bf16_f32 v76, v76, v77
    v_cvt_pk_bf16_f32 v77, v78, v79
    ds_write_b64 v237, v[76:77] offset:48
    v_pk_mul_f32 v[80:81], v[80:81], v[30:31] op_sel_hi:[1,0]
    v_pk_mul_f32 v[82:83], v[82:83], v[30:31] op_sel_hi:[1,0]
    v_cvt_pk_bf16_f32 v80, v80, v81
    v_cvt_pk_bf16_f32 v81, v82, v83
    ds_write_b64 v237, v[80:81] offset:64
    v_pk_mul_f32 v[84:85], v[84:85], v[30:31] op_sel_hi:[1,0]
    v_pk_mul_f32 v[86:87], v[86:87], v[30:31] op_sel_hi:[1,0]
    v_cvt_pk_bf16_f32 v84, v84, v85
    v_cvt_pk_bf16_f32 v85, v86, v87
    ds_write_b64 v237, v[84:85] offset:80
    v_pk_mul_f32 v[88:89], v[88:89], v[30:31] op_sel_hi:[1,0]
    v_pk_mul_f32 v[90:91], v[90:91], v[30:31] op_sel_hi:[1,0]
    v_cvt_pk_bf16_f32 v88, v88, v89
    v_cvt_pk_bf16_f32 v89, v90, v91
    ds_write_b64 v237, v[88:89] offset:96
    v_pk_mul_f32 v[92:93], v[92:93], v[30:31] op_sel_hi:[1,0]
    v_pk_mul_f32 v[94:95], v[94:95], v[30:31] op_sel_hi:[1,0]
    v_cvt_pk_bf16_f32 v92, v92, v93
    v_cvt_pk_bf16_f32 v93, v94, v95
    ds_write_b64 v237, v[92:93] offset:112
    v_pk_mul_f32 v[96:97], v[96:97], v[30:31] op_sel_hi:[1,0]
    v_pk_mul_f32 v[98:99], v[98:99], v[30:31] op_sel_hi:[1,0]
    v_cvt_pk_bf16_f32 v96, v96, v97
    v_cvt_pk_bf16_f32 v97, v98, v99
    ds_write_b64 v237, v[96:97] offset:128
    v_pk_mul_f32 v[100:101], v[100:101], v[30:31] op_sel_hi:[1,0]
    v_pk_mul_f32 v[102:103], v[102:103], v[30:31] op_sel_hi:[1,0]
    v_cvt_pk_bf16_f32 v100, v100, v101
    v_cvt_pk_bf16_f32 v101, v102, v103
    ds_write_b64 v237, v[100:101] offset:144
    v_pk_mul_f32 v[104:105], v[104:105], v[30:31] op_sel_hi:[1,0]
    v_pk_mul_f32 v[106:107], v[106:107], v[30:31] op_sel_hi:[1,0]
    v_cvt_pk_bf16_f32 v104, v104, v105
    v_cvt_pk_bf16_f32 v105, v106, v107
    ds_write_b64 v237, v[104:105] offset:160
    v_pk_mul_f32 v[108:109], v[108:109], v[30:31] op_sel_hi:[1,0]
    v_pk_mul_f32 v[110:111], v[110:111], v[30:31] op_sel_hi:[1,0]
    v_cvt_pk_bf16_f32 v108, v108, v109
    v_cvt_pk_bf16_f32 v109, v110, v111
    ds_write_b64 v237, v[108:109] offset:176
    v_pk_mul_f32 v[112:113], v[112:113], v[30:31] op_sel_hi:[1,0]
    v_pk_mul_f32 v[114:115], v[114:115], v[30:31] op_sel_hi:[1,0]
    v_cvt_pk_bf16_f32 v112, v112, v113
    v_cvt_pk_bf16_f32 v113, v114, v115
    ds_write_b64 v237, v[112:113] offset:192
    v_pk_mul_f32 v[116:117], v[116:117], v[30:31] op_sel_hi:[1,0]
    v_pk_mul_f32 v[118:119], v[118:119], v[30:31] op_sel_hi:[1,0]
    v_cvt_pk_bf16_f32 v116, v116, v117
    v_cvt_pk_bf16_f32 v117, v118, v119
    ds_write_b64 v237, v[116:117] offset:208
    v_pk_mul_f32 v[120:121], v[120:121], v[30:31] op_sel_hi:[1,0]
    v_pk_mul_f32 v[122:123], v[122:123], v[30:31] op_sel_hi:[1,0]
    v_cvt_pk_bf16_f32 v120, v120, v121
    v_cvt_pk_bf16_f32 v121, v122, v123
    ds_write_b64 v237, v[120:121] offset:224
    v_pk_mul_f32 v[124:125], v[124:125], v[30:31] op_sel_hi:[1,0]
    v_pk_mul_f32 v[126:127], v[126:127], v[30:31] op_sel_hi:[1,0]
    v_cvt_pk_bf16_f32 v124, v124, v125
    v_cvt_pk_bf16_f32 v125, v126, v127
    ds_write_b64 v237, v[124:125] offset:240
    s_waitcnt lgkmcnt(0)
    s_branch L_E0
L_TRANS:
    s_mov_b32 s40, 33
L_IDLE3_LOOP:
    s_barrier
    s_sub_u32 s40, s40, 1
    s_cmp_lg_u32 s40, 0
    s_cbranch_scc1 L_IDLE3_LOOP
    s_barrier
    v_add_u32 v245, 0x8000, v244
    v_xor_b32 v246, 32, v245
    ds_read_b64_tr_b16 v[128:129], v245 offset:0
    ds_read_b64_tr_b16 v[130:131], v245 offset:1024
    ds_read_b64_tr_b16 v[132:133], v246 offset:0
    ds_read_b64_tr_b16 v[134:135], v246 offset:1024
    ds_read_b64_tr_b16 v[136:137], v245 offset:8192
    ds_read_b64_tr_b16 v[138:139], v245 offset:9216
    ds_read_b64_tr_b16 v[140:141], v246 offset:8192
    ds_read_b64_tr_b16 v[142:143], v246 offset:9216
    ds_read_b64_tr_b16 v[144:145], v245 offset:16384
    ds_read_b64_tr_b16 v[146:147], v245 offset:17408
    ds_read_b64_tr_b16 v[148:149], v246 offset:16384
    ds_read_b64_tr_b16 v[150:151], v246 offset:17408
    ds_read_b64_tr_b16 v[152:153], v245 offset:24576
    ds_read_b64_tr_b16 v[154:155], v245 offset:25600
    ds_read_b64_tr_b16 v[156:157], v246 offset:24576
    ds_read_b64_tr_b16 v[158:159], v246 offset:25600
    s_waitcnt lgkmcnt(0)
L_E0:
    s_barrier
    ds_read_b128 v[32:35], v240 offset:0
    ds_read_b128 v[36:39], v240 offset:4352
    ds_read_b128 v[40:43], v240 offset:8704
    ds_read_b128 v[44:47], v240 offset:64
    ds_read_b128 v[48:51], v240 offset:4416
    ds_read_b128 v[52:55], v240 offset:8768
    ds_read_b128 v[56:59], v240 offset:128
    ds_read_b128 v[60:63], v240 offset:4480
    ds_read_b128 v[64:67], v240 offset:8832
    ds_read_b128 v[68:71], v240 offset:192
    ds_read_b128 v[72:75], v240 offset:4544
    ds_read_b128 v[76:79], v240 offset:8896
    s_waitcnt lgkmcnt(0)
    s_barrier
    v_mfma_f32_16x16x32_bf16 v[192:195], v[128:131], v[32:35], 0
    ds_read_b128 v[80:83], v240 offset:13056
    v_mfma_f32_16x16x32_bf16 v[200:203], v[128:131], v[36:39], 0
    ds_read_b128 v[84:87], v240 offset:17408
    v_mfma_f32_16x16x32_bf16 v[208:211], v[128:131], v[40:43], 0
    ds_read_b128 v[88:91], v240 offset:21760
    v_mfma_f32_16x16x32_bf16 v[196:199], v[132:135], v[32:35], 0
    ds_read_b128 v[92:95], v240 offset:13120
    ds_read_b128 v[96:99], v240 offset:17472
    v_mfma_f32_16x16x32_bf16 v[204:207], v[132:135], v[36:39], 0
    ds_read_b128 v[100:103], v240 offset:21824
    v_mfma_f32_16x16x32_bf16 v[212:215], v[132:135], v[40:43], 0
    ds_read_b128 v[104:107], v240 offset:13184
    v_mfma_f32_16x16x32_bf16 v[192:195], v[136:139], v[44:47], v[192:195]
    ds_read_b128 v[108:111], v240 offset:17536
    v_mfma_f32_16x16x32_bf16 v[200:203], v[136:139], v[48:51], v[200:203]
    ds_read_b128 v[112:115], v240 offset:21888
    ds_read_b128 v[116:119], v240 offset:13248
    v_mfma_f32_16x16x32_bf16 v[208:211], v[136:139], v[52:55], v[208:211]
    ds_read_b128 v[120:123], v240 offset:17600
    v_mfma_f32_16x16x32_bf16 v[196:199], v[140:143], v[44:47], v[196:199]
    ds_read_b128 v[124:127], v240 offset:21952
    v_add_u32 v245, 0x10000, v244
    v_mfma_f32_16x16x32_bf16 v[204:207], v[140:143], v[48:51], v[204:207]
    v_xor_b32_e64 v246, 32, v245
    v_mfma_f32_16x16x32_bf16 v[212:215], v[140:143], v[52:55], v[212:215]
    ds_read_b64_tr_b16 v[160:161], v245 offset:0
    ds_read_b64_tr_b16 v[162:163], v245 offset:1024
    v_mfma_f32_16x16x32_bf16 v[192:195], v[144:147], v[56:59], v[192:195]
    ds_read_b64_tr_b16 v[164:165], v246 offset:0
    v_mfma_f32_16x16x32_bf16 v[200:203], v[144:147], v[60:63], v[200:203]
    ds_read_b64_tr_b16 v[166:167], v246 offset:1024
    v_mfma_f32_16x16x32_bf16 v[208:211], v[144:147], v[64:67], v[208:211]
    ds_read_b64_tr_b16 v[168:169], v245 offset:8192
    v_mfma_f32_16x16x32_bf16 v[196:199], v[148:151], v[56:59], v[196:199]
    ds_read_b64_tr_b16 v[170:171], v245 offset:9216
    ds_read_b64_tr_b16 v[172:173], v246 offset:8192
    v_mfma_f32_16x16x32_bf16 v[204:207], v[148:151], v[60:63], v[204:207]
    ds_read_b64_tr_b16 v[174:175], v246 offset:9216
    v_mfma_f32_16x16x32_bf16 v[212:215], v[148:151], v[64:67], v[212:215]
    ds_read_b64_tr_b16 v[176:177], v245 offset:16384
    v_mfma_f32_16x16x32_bf16 v[192:195], v[152:155], v[68:71], v[192:195]
    ds_read_b64_tr_b16 v[178:179], v245 offset:17408
    v_mfma_f32_16x16x32_bf16 v[200:203], v[152:155], v[72:75], v[200:203]
    ds_read_b64_tr_b16 v[180:181], v246 offset:16384
    ds_read_b64_tr_b16 v[182:183], v246 offset:17408
    v_mfma_f32_16x16x32_bf16 v[208:211], v[152:155], v[76:79], v[208:211]
    ds_read_b64_tr_b16 v[184:185], v245 offset:24576
    v_mfma_f32_16x16x32_bf16 v[196:199], v[156:159], v[68:71], v[196:199]
    ds_read_b64_tr_b16 v[186:187], v245 offset:25600
    v_mfma_f32_16x16x32_bf16 v[204:207], v[156:159], v[72:75], v[204:207]
    ds_read_b64_tr_b16 v[188:189], v246 offset:24576
    v_mfma_f32_16x16x32_bf16 v[212:215], v[156:159], v[76:79], v[212:215]
    ds_read_b64_tr_b16 v[190:191], v246 offset:25600
    s_waitcnt lgkmcnt(0)
    s_barrier
    v_mfma_f32_16x16x32_bf16 v[192:195], v[160:163], v[80:83], v[192:195]
    v_add_u32 v245, 0x0, v244
    v_xor_b32 v246, 32, v245
    v_mfma_f32_16x16x32_bf16 v[200:203], v[160:163], v[84:87], v[200:203]
    ds_read_b64_tr_b16 v[128:129], v245 offset:0
    v_mfma_f32_16x16x32_bf16 v[208:211], v[160:163], v[88:91], v[208:211]
    ds_read_b64_tr_b16 v[130:131], v245 offset:1024
    v_mfma_f32_16x16x32_bf16 v[196:199], v[164:167], v[80:83], v[196:199]
    ds_read_b64_tr_b16 v[132:133], v246 offset:0
    v_mfma_f32_16x16x32_bf16 v[204:207], v[164:167], v[84:87], v[204:207]
    ds_read_b64_tr_b16 v[134:135], v246 offset:1024
    v_mfma_f32_16x16x32_bf16 v[212:215], v[164:167], v[88:91], v[212:215]
    ds_read_b64_tr_b16 v[136:137], v245 offset:8192
    v_mfma_f32_16x16x32_bf16 v[192:195], v[168:171], v[92:95], v[192:195]
    ds_read_b64_tr_b16 v[138:139], v245 offset:9216
    v_mfma_f32_16x16x32_bf16 v[200:203], v[168:171], v[96:99], v[200:203]
    ds_read_b64_tr_b16 v[140:141], v246 offset:8192
    v_mfma_f32_16x16x32_bf16 v[208:211], v[168:171], v[100:103], v[208:211]
    ds_read_b64_tr_b16 v[142:143], v246 offset:9216
    v_mfma_f32_16x16x32_bf16 v[196:199], v[172:175], v[92:95], v[196:199]
    ds_read_b64_tr_b16 v[144:145], v245 offset:16384
    v_mfma_f32_16x16x32_bf16 v[204:207], v[172:175], v[96:99], v[204:207]
    ds_read_b64_tr_b16 v[146:147], v245 offset:17408
    v_mfma_f32_16x16x32_bf16 v[212:215], v[172:175], v[100:103], v[212:215]
    ds_read_b64_tr_b16 v[148:149], v246 offset:16384
    v_mfma_f32_16x16x32_bf16 v[192:195], v[176:179], v[104:107], v[192:195]
    ds_read_b64_tr_b16 v[150:151], v246 offset:17408
    v_mfma_f32_16x16x32_bf16 v[200:203], v[176:179], v[108:111], v[200:203]
    ds_read_b64_tr_b16 v[152:153], v245 offset:24576
    v_mfma_f32_16x16x32_bf16 v[208:211], v[176:179], v[112:115], v[208:211]
    ds_read_b64_tr_b16 v[154:155], v245 offset:25600
    v_mfma_f32_16x16x32_bf16 v[196:199], v[180:183], v[104:107], v[196:199]
    ds_read_b64_tr_b16 v[156:157], v246 offset:24576
    v_mfma_f32_16x16x32_bf16 v[204:207], v[180:183], v[108:111], v[204:207]
    ds_read_b64_tr_b16 v[158:159], v246 offset:25600
    v_mfma_f32_16x16x32_bf16 v[212:215], v[180:183], v[112:115], v[212:215]
    v_mfma_f32_16x16x32_bf16 v[192:195], v[184:187], v[116:119], v[192:195]
    v_mfma_f32_16x16x32_bf16 v[200:203], v[184:187], v[120:123], v[200:203]
    v_mfma_f32_16x16x32_bf16 v[208:211], v[184:187], v[124:127], v[208:211]
    v_mfma_f32_16x16x32_bf16 v[196:199], v[188:191], v[116:119], v[196:199]
    v_mfma_f32_16x16x32_bf16 v[204:207], v[188:191], v[120:123], v[204:207]
    v_mfma_f32_16x16x32_bf16 v[212:215], v[188:191], v[124:127], v[212:215]
    s_waitcnt lgkmcnt(0)
    s_barrier
    v_mfma_f32_16x16x32_bf16 v[216:219], v[128:131], v[32:35], 0
    v_add_u32 v245, 0x20000, v244
    v_xor_b32_e64 v246, 32, v245
    v_mfma_f32_16x16x32_bf16 v[224:227], v[128:131], v[36:39], 0
    ds_read_b64_tr_b16 v[160:161], v245 offset:0
    v_mfma_f32_16x16x32_bf16 v[232:235], v[128:131], v[40:43], 0
    ds_read_b64_tr_b16 v[162:163], v245 offset:1024
    v_mfma_f32_16x16x32_bf16 v[220:223], v[132:135], v[32:35], 0
    ds_read_b64_tr_b16 v[164:165], v246 offset:0
    ds_read_b64_tr_b16 v[166:167], v246 offset:1024
    v_mfma_f32_16x16x32_bf16 v[228:231], v[132:135], v[36:39], 0
    ds_read_b64_tr_b16 v[168:169], v245 offset:8192
    v_mfma_f32_16x16x32_bf16 v[236:239], v[132:135], v[40:43], 0
    ds_read_b64_tr_b16 v[170:171], v245 offset:9216
    v_mfma_f32_16x16x32_bf16 v[216:219], v[136:139], v[44:47], v[216:219]
    ds_read_b64_tr_b16 v[172:173], v246 offset:8192
    v_mfma_f32_16x16x32_bf16 v[224:227], v[136:139], v[48:51], v[224:227]
    ds_read_b64_tr_b16 v[174:175], v246 offset:9216
    ds_read_b64_tr_b16 v[176:177], v245 offset:16384
    v_mfma_f32_16x16x32_bf16 v[232:235], v[136:139], v[52:55], v[232:235]
    ds_read_b64_tr_b16 v[178:179], v245 offset:17408
    v_mfma_f32_16x16x32_bf16 v[220:223], v[140:143], v[44:47], v[220:223]
    ds_read_b64_tr_b16 v[180:181], v246 offset:16384
    v_mfma_f32_16x16x32_bf16 v[228:231], v[140:143], v[48:51], v[228:231]
    ds_read_b64_tr_b16 v[182:183], v246 offset:17408
    v_mfma_f32_16x16x32_bf16 v[236:239], v[140:143], v[52:55], v[236:239]
    ds_read_b64_tr_b16 v[184:185], v245 offset:24576
    ds_read_b64_tr_b16 v[186:187], v245 offset:25600
    v_mfma_f32_16x16x32_bf16 v[216:219], v[144:147], v[56:59], v[216:219]
    ds_read_b64_tr_b16 v[188:189], v246 offset:24576
    v_mfma_f32_16x16x32_bf16 v[224:227], v[144:147], v[60:63], v[224:227]
    ds_read_b64_tr_b16 v[190:191], v246 offset:25600
    v_cvt_pk_bf16_f32 v192, v192, v193
    v_mfma_f32_16x16x32_bf16 v[232:235], v[144:147], v[64:67], v[232:235]
    v_cvt_pk_bf16_f32 v193, v194, v195
    v_cvt_pk_bf16_f32 v194, v196, v197
    v_mfma_f32_16x16x32_bf16 v[220:223], v[148:151], v[56:59], v[220:223]
    v_cvt_pk_bf16_f32 v195, v198, v199
    v_cvt_pk_bf16_f32 v200, v200, v201
    v_cvt_pk_bf16_f32 v201, v202, v203
    v_mfma_f32_16x16x32_bf16 v[228:231], v[148:151], v[60:63], v[228:231]
    v_cvt_pk_bf16_f32 v202, v204, v205
    v_cvt_pk_bf16_f32 v203, v206, v207
    v_mfma_f32_16x16x32_bf16 v[236:239], v[148:151], v[64:67], v[236:239]
    v_cvt_pk_bf16_f32 v208, v208, v209
    v_cvt_pk_bf16_f32 v209, v210, v211
    v_cvt_pk_bf16_f32 v210, v212, v213
    v_mfma_f32_16x16x32_bf16 v[216:219], v[152:155], v[68:71], v[216:219]
    v_cvt_pk_bf16_f32 v211, v214, v215
    s_add_u32 s32, s4, 0
    v_mfma_f32_16x16x32_bf16 v[224:227], v[152:155], v[72:75], v[224:227]
    s_and_b32 s32, s32, 3
    s_mul_i32 s32, s32, 196608
    s_add_u32 s32, s32, s43
    v_mfma_f32_16x16x32_bf16 v[232:235], v[152:155], v[76:79], v[232:235]
    buffer_store_dwordx4 v[192:195], v247, s[28:31], s32 offen offset:0 sc1
    v_mfma_f32_16x16x32_bf16 v[220:223], v[156:159], v[68:71], v[220:223]
    buffer_store_dwordx4 v[200:203], v247, s[28:31], s32 offen offset:1024 sc1
    v_mfma_f32_16x16x32_bf16 v[228:231], v[156:159], v[72:75], v[228:231]
    buffer_store_dwordx4 v[208:211], v247, s[28:31], s32 offen offset:2048 sc1
    v_mfma_f32_16x16x32_bf16 v[236:239], v[156:159], v[76:79], v[236:239]
    s_waitcnt lgkmcnt(0)
    s_barrier
    v_mfma_f32_16x16x32_bf16 v[216:219], v[160:163], v[80:83], v[216:219]
    v_add_u32 v245, 0x8000, v244
    v_xor_b32 v246, 32, v245
    v_mfma_f32_16x16x32_bf16 v[224:227], v[160:163], v[84:87], v[224:227]
    ds_read_b64_tr_b16 v[128:129], v245 offset:0
    v_mfma_f32_16x16x32_bf16 v[232:235], v[160:163], v[88:91], v[232:235]
    ds_read_b64_tr_b16 v[130:131], v245 offset:1024
    v_mfma_f32_16x16x32_bf16 v[220:223], v[164:167], v[80:83], v[220:223]
    ds_read_b64_tr_b16 v[132:133], v246 offset:0
    v_mfma_f32_16x16x32_bf16 v[228:231], v[164:167], v[84:87], v[228:231]
    ds_read_b64_tr_b16 v[134:135], v246 offset:1024
    v_mfma_f32_16x16x32_bf16 v[236:239], v[164:167], v[88:91], v[236:239]
    ds_read_b64_tr_b16 v[136:137], v245 offset:8192
    v_mfma_f32_16x16x32_bf16 v[216:219], v[168:171], v[92:95], v[216:219]
    ds_read_b64_tr_b16 v[138:139], v245 offset:9216
    v_mfma_f32_16x16x32_bf16 v[224:227], v[168:171], v[96:99], v[224:227]
    ds_read_b64_tr_b16 v[140:141], v246 offset:8192
    v_mfma_f32_16x16x32_bf16 v[232:235], v[168:171], v[100:103], v[232:235]
    ds_read_b64_tr_b16 v[142:143], v246 offset:9216
    v_mfma_f32_16x16x32_bf16 v[220:223], v[172:175], v[92:95], v[220:223]
    ds_read_b64_tr_b16 v[144:145], v245 offset:16384
    v_mfma_f32_16x16x32_bf16 v[228:231], v[172:175], v[96:99], v[228:231]
    ds_read_b64_tr_b16 v[146:147], v245 offset:17408
    v_mfma_f32_16x16x32_bf16 v[236:239], v[172:175], v[100:103], v[236:239]
    ds_read_b64_tr_b16 v[148:149], v246 offset:16384
    v_mfma_f32_16x16x32_bf16 v[216:219], v[176:179], v[104:107], v[216:219]
    ds_read_b64_tr_b16 v[150:151], v246 offset:17408
    v_mfma_f32_16x16x32_bf16 v[224:227], v[176:179], v[108:111], v[224:227]
    ds_read_b64_tr_b16 v[152:153], v245 offset:24576
    v_mfma_f32_16x16x32_bf16 v[232:235], v[176:179], v[112:115], v[232:235]
    ds_read_b64_tr_b16 v[154:155], v245 offset:25600
    v_mfma_f32_16x16x32_bf16 v[220:223], v[180:183], v[104:107], v[220:223]
    ds_read_b64_tr_b16 v[156:157], v246 offset:24576
    v_mfma_f32_16x16x32_bf16 v[228:231], v[180:183], v[108:111], v[228:231]
    ds_read_b64_tr_b16 v[158:159], v246 offset:25600
    v_mfma_f32_16x16x32_bf16 v[236:239], v[180:183], v[112:115], v[236:239]
    v_mfma_f32_16x16x32_bf16 v[216:219], v[184:187], v[116:119], v[216:219]
    v_mfma_f32_16x16x32_bf16 v[224:227], v[184:187], v[120:123], v[224:227]
    v_mfma_f32_16x16x32_bf16 v[232:235], v[184:187], v[124:127], v[232:235]
    v_mfma_f32_16x16x32_bf16 v[220:223], v[188:191], v[116:119], v[220:223]
    v_mfma_f32_16x16x32_bf16 v[228:231], v[188:191], v[120:123], v[228:231]
    v_mfma_f32_16x16x32_bf16 v[236:239], v[188:191], v[124:127], v[236:239]
    s_waitcnt lgkmcnt(0)
    s_barrier
    v_mfma_f32_16x16x32_bf16 v[192:195], v[128:131], v[32:35], 0
    v_add_u32 v245, 0x10000, v244
    v_xor_b32_e64 v246, 32, v245
    v_mfma_f32_16x16x32_bf16 v[200:203], v[128:131], v[36:39], 0
    ds_read_b64_tr_b16 v[160:161], v245 offset:0
    v_mfma_f32_16x16x32_bf16 v[208:211], v[128:131], v[40:43], 0
    ds_read_b64_tr_b16 v[162:163], v245 offset:1024
    v_mfma_f32_16x16x32_bf16 v[196:199], v[132:135], v[32:35], 0
    ds_read_b64_tr_b16 v[164:165], v246 offset:0
    ds_read_b64_tr_b16 v[166:167], v246 offset:1024
    v_mfma_f32_16x16x32_bf16 v[204:207], v[132:135], v[36:39], 0
    ds_read_b64_tr_b16 v[168:169], v245 offset:8192
    v_mfma_f32_16x16x32_bf16 v[212:215], v[132:135], v[40:43], 0
    ds_read_b64_tr_b16 v[170:171], v245 offset:9216
    v_mfma_f32_16x16x32_bf16 v[192:195], v[136:139], v[44:47], v[192:195]
    ds_read_b64_tr_b16 v[172:173], v246 offset:8192
    v_mfma_f32_16x16x32_bf16 v[200:203], v[136:139], v[48:51], v[200:203]
    ds_read_b64_tr_b16 v[174:175], v246 offset:9216
    ds_read_b64_tr_b16 v[176:177], v245 offset:16384
    v_mfma_f32_16x16x32_bf16 v[208:211], v[136:139], v[52:55], v[208:211]
    ds_read_b64_tr_b16 v[178:179], v245 offset:17408
    v_mfma_f32_16x16x32_bf16 v[196:199], v[140:143], v[44:47], v[196:199]
    ds_read_b64_tr_b16 v[180:181], v246 offset:16384
    v_mfma_f32_16x16x32_bf16 v[204:207], v[140:143], v[48:51], v[204:207]
    ds_read_b64_tr_b16 v[182:183], v246 offset:17408
    v_mfma_f32_16x16x32_bf16 v[212:215], v[140:143], v[52:55], v[212:215]
    ds_read_b64_tr_b16 v[184:185], v245 offset:24576
    ds_read_b64_tr_b16 v[186:187], v245 offset:25600
    v_mfma_f32_16x16x32_bf16 v[192:195], v[144:147], v[56:59], v[192:195]
    ds_read_b64_tr_b16 v[188:189], v246 offset:24576
    v_mfma_f32_16x16x32_bf16 v[200:203], v[144:147], v[60:63], v[200:203]
    ds_read_b64_tr_b16 v[190:191], v246 offset:25600
    v_cvt_pk_bf16_f32 v216, v216, v217
    v_mfma_f32_16x16x32_bf16 v[208:211], v[144:147], v[64:67], v[208:211]
    v_cvt_pk_bf16_f32 v217, v218, v219
    v_cvt_pk_bf16_f32 v218, v220, v221
    v_mfma_f32_16x16x32_bf16 v[196:199], v[148:151], v[56:59], v[196:199]
    v_cvt_pk_bf16_f32 v219, v222, v223
    v_cvt_pk_bf16_f32 v224, v224, v225
    v_cvt_pk_bf16_f32 v225, v226, v227
    v_mfma_f32_16x16x32_bf16 v[204:207], v[148:151], v[60:63], v[204:207]
    v_cvt_pk_bf16_f32 v226, v228, v229
    v_cvt_pk_bf16_f32 v227, v230, v231
    v_mfma_f32_16x16x32_bf16 v[212:215], v[148:151], v[64:67], v[212:215]
    v_cvt_pk_bf16_f32 v232, v232, v233
    v_cvt_pk_bf16_f32 v233, v234, v235
    v_cvt_pk_bf16_f32 v234, v236, v237
    v_mfma_f32_16x16x32_bf16 v[192:195], v[152:155], v[68:71], v[192:195]
    v_cvt_pk_bf16_f32 v235, v238, v239
    s_add_u32 s32, s4, 1
    v_mfma_f32_16x16x32_bf16 v[200:203], v[152:155], v[72:75], v[200:203]
    s_and_b32 s32, s32, 3
    s_mul_i32 s32, s32, 196608
    s_add_u32 s32, s32, s43
    v_mfma_f32_16x16x32_bf16 v[208:211], v[152:155], v[76:79], v[208:211]
    buffer_store_dwordx4 v[216:219], v247, s[28:31], s32 offen offset:0 sc1
    v_mfma_f32_16x16x32_bf16 v[196:199], v[156:159], v[68:71], v[196:199]
    buffer_store_dwordx4 v[224:227], v247, s[28:31], s32 offen offset:1024 sc1
    v_mfma_f32_16x16x32_bf16 v[204:207], v[156:159], v[72:75], v[204:207]
    buffer_store_dwordx4 v[232:235], v247, s[28:31], s32 offen offset:2048 sc1
    v_mfma_f32_16x16x32_bf16 v[212:215], v[156:159], v[76:79], v[212:215]
    s_waitcnt lgkmcnt(0)
    s_barrier
    v_mfma_f32_16x16x32_bf16 v[192:195], v[160:163], v[80:83], v[192:195]
    v_add_u32 v245, 0x0, v244
    v_xor_b32_e64 v246, 32, v245
    v_mfma_f32_16x16x32_bf16 v[200:203], v[160:163], v[84:87], v[200:203]
    ds_read_b64_tr_b16 v[128:129], v245 offset:0
    v_mfma_f32_16x16x32_bf16 v[208:211], v[160:163], v[88:91], v[208:211]
    ds_read_b64_tr_b16 v[130:131], v245 offset:1024
    v_mfma_f32_16x16x32_bf16 v[196:199], v[164:167], v[80:83], v[196:199]
    ds_read_b64_tr_b16 v[132:133], v246 offset:0
    v_mfma_f32_16x16x32_bf16 v[204:207], v[164:167], v[84:87], v[204:207]
    ds_read_b64_tr_b16 v[134:135], v246 offset:1024
    v_mfma_f32_16x16x32_bf16 v[212:215], v[164:167], v[88:91], v[212:215]
    ds_read_b64_tr_b16 v[136:137], v245 offset:8192
    v_mfma_f32_16x16x32_bf16 v[192:195], v[168:171], v[92:95], v[192:195]
    ds_read_b64_tr_b16 v[138:139], v245 offset:9216
    v_mfma_f32_16x16x32_bf16 v[200:203], v[168:171], v[96:99], v[200:203]
    ds_read_b64_tr_b16 v[140:141], v246 offset:8192
    v_mfma_f32_16x16x32_bf16 v[208:211], v[168:171], v[100:103], v[208:211]
    ds_read_b64_tr_b16 v[142:143], v246 offset:9216
    v_mfma_f32_16x16x32_bf16 v[196:199], v[172:175], v[92:95], v[196:199]
    ds_read_b64_tr_b16 v[144:145], v245 offset:16384
    v_mfma_f32_16x16x32_bf16 v[204:207], v[172:175], v[96:99], v[204:207]
    ds_read_b64_tr_b16 v[146:147], v245 offset:17408
    v_mfma_f32_16x16x32_bf16 v[212:215], v[172:175], v[100:103], v[212:215]
    ds_read_b64_tr_b16 v[148:149], v246 offset:16384
    v_mfma_f32_16x16x32_bf16 v[192:195], v[176:179], v[104:107], v[192:195]
    ds_read_b64_tr_b16 v[150:151], v246 offset:17408
    v_mfma_f32_16x16x32_bf16 v[200:203], v[176:179], v[108:111], v[200:203]
    ds_read_b64_tr_b16 v[152:153], v245 offset:24576
    v_mfma_f32_16x16x32_bf16 v[208:211], v[176:179], v[112:115], v[208:211]
    ds_read_b64_tr_b16 v[154:155], v245 offset:25600
    v_mfma_f32_16x16x32_bf16 v[196:199], v[180:183], v[104:107], v[196:199]
    ds_read_b64_tr_b16 v[156:157], v246 offset:24576
    v_mfma_f32_16x16x32_bf16 v[204:207], v[180:183], v[108:111], v[204:207]
    ds_read_b64_tr_b16 v[158:159], v246 offset:25600
    v_mfma_f32_16x16x32_bf16 v[212:215], v[180:183], v[112:115], v[212:215]
    v_mfma_f32_16x16x32_bf16 v[192:195], v[184:187], v[116:119], v[192:195]
    v_mfma_f32_16x16x32_bf16 v[200:203], v[184:187], v[120:123], v[200:203]
    v_mfma_f32_16x16x32_bf16 v[208:211], v[184:187], v[124:127], v[208:211]
    v_mfma_f32_16x16x32_bf16 v[196:199], v[188:191], v[116:119], v[196:199]
    v_mfma_f32_16x16x32_bf16 v[204:207], v[188:191], v[120:123], v[204:207]
    v_mfma_f32_16x16x32_bf16 v[212:215], v[188:191], v[124:127], v[212:215]
    s_waitcnt lgkmcnt(0)
    s_barrier
    v_mfma_f32_16x16x32_bf16 v[216:219], v[128:131], v[32:35], 0
    v_add_u32 v245, 0x20000, v244
    v_xor_b32_e64 v246, 32, v245
    v_mfma_f32_16x16x32_bf16 v[224:227], v[128:131], v[36:39], 0
    ds_read_b64_tr_b16 v[160:161], v245 offset:0
    v_mfma_f32_16x16x32_bf16 v[232:235], v[128:131], v[40:43], 0
    ds_read_b64_tr_b16 v[162:163], v245 offset:1024
    v_mfma_f32_16x16x32_bf16 v[220:223], v[132:135], v[32:35], 0
    ds_read_b64_tr_b16 v[164:165], v246 offset:0
    ds_read_b64_tr_b16 v[166:167], v246 offset:1024
    v_mfma_f32_16x16x32_bf16 v[228:231], v[132:135], v[36:39], 0
    ds_read_b64_tr_b16 v[168:169], v245 offset:8192
    v_mfma_f32_16x16x32_bf16 v[236:239], v[132:135], v[40:43], 0
    ds_read_b64_tr_b16 v[170:171], v245 offset:9216
    v_mfma_f32_16x16x32_bf16 v[216:219], v[136:139], v[44:47], v[216:219]
    ds_read_b64_tr_b16 v[172:173], v246 offset:8192
    v_mfma_f32_16x16x32_bf16 v[224:227], v[136:139], v[48:51], v[224:227]
    ds_read_b64_tr_b16 v[174:175], v246 offset:9216
    ds_read_b64_tr_b16 v[176:177], v245 offset:16384
    v_mfma_f32_16x16x32_bf16 v[232:235], v[136:139], v[52:55], v[232:235]
    ds_read_b64_tr_b16 v[178:179], v245 offset:17408
    v_mfma_f32_16x16x32_bf16 v[220:223], v[140:143], v[44:47], v[220:223]
    ds_read_b64_tr_b16 v[180:181], v246 offset:16384
    v_mfma_f32_16x16x32_bf16 v[228:231], v[140:143], v[48:51], v[228:231]
    ds_read_b64_tr_b16 v[182:183], v246 offset:17408
    v_mfma_f32_16x16x32_bf16 v[236:239], v[140:143], v[52:55], v[236:239]
    ds_read_b64_tr_b16 v[184:185], v245 offset:24576
    ds_read_b64_tr_b16 v[186:187], v245 offset:25600
    v_mfma_f32_16x16x32_bf16 v[216:219], v[144:147], v[56:59], v[216:219]
    ds_read_b64_tr_b16 v[188:189], v246 offset:24576
    v_mfma_f32_16x16x32_bf16 v[224:227], v[144:147], v[60:63], v[224:227]
    ds_read_b64_tr_b16 v[190:191], v246 offset:25600
    v_cvt_pk_bf16_f32 v192, v192, v193
    v_mfma_f32_16x16x32_bf16 v[232:235], v[144:147], v[64:67], v[232:235]
    v_cvt_pk_bf16_f32 v193, v194, v195
    v_cvt_pk_bf16_f32 v194, v196, v197
    v_mfma_f32_16x16x32_bf16 v[220:223], v[148:151], v[56:59], v[220:223]
    v_cvt_pk_bf16_f32 v195, v198, v199
    v_cvt_pk_bf16_f32 v200, v200, v201
    v_cvt_pk_bf16_f32 v201, v202, v203
    v_mfma_f32_16x16x32_bf16 v[228:231], v[148:151], v[60:63], v[228:231]
    v_cvt_pk_bf16_f32 v202, v204, v205
    v_cvt_pk_bf16_f32 v203, v206, v207
    v_mfma_f32_16x16x32_bf16 v[236:239], v[148:151], v[64:67], v[236:239]
    v_cvt_pk_bf16_f32 v208, v208, v209
    v_cvt_pk_bf16_f32 v209, v210, v211
    v_cvt_pk_bf16_f32 v210, v212, v213
    v_mfma_f32_16x16x32_bf16 v[216:219], v[152:155], v[68:71], v[216:219]
    v_cvt_pk_bf16_f32 v211, v214, v215
    s_add_u32 s32, s4, 2
    v_mfma_f32_16x16x32_bf16 v[224:227], v[152:155], v[72:75], v[224:227]
    s_and_b32 s32, s32, 3
    s_mul_i32 s32, s32, 196608
    s_add_u32 s32, s32, s43
    v_mfma_f32_16x16x32_bf16 v[232:235], v[152:155], v[76:79], v[232:235]
    buffer_store_dwordx4 v[192:195], v247, s[28:31], s32 offen offset:0 sc1
    v_mfma_f32_16x16x32_bf16 v[220:223], v[156:159], v[68:71], v[220:223]
    buffer_store_dwordx4 v[200:203], v247, s[28:31], s32 offen offset:1024 sc1
    v_mfma_f32_16x16x32_bf16 v[228:231], v[156:159], v[72:75], v[228:231]
    buffer_store_dwordx4 v[208:211], v247, s[28:31], s32 offen offset:2048 sc1
    v_mfma_f32_16x16x32_bf16 v[236:239], v[156:159], v[76:79], v[236:239]
    s_waitcnt lgkmcnt(0)
    v_mfma_f32_16x16x32_bf16 v[216:219], v[160:163], v[80:83], v[216:219]
    v_mfma_f32_16x16x32_bf16 v[224:227], v[160:163], v[84:87], v[224:227]
    v_mfma_f32_16x16x32_bf16 v[232:235], v[160:163], v[88:91], v[232:235]
    v_mfma_f32_16x16x32_bf16 v[220:223], v[164:167], v[80:83], v[220:223]
    v_mfma_f32_16x16x32_bf16 v[228:231], v[164:167], v[84:87], v[228:231]
    v_mfma_f32_16x16x32_bf16 v[236:239], v[164:167], v[88:91], v[236:239]
    v_mfma_f32_16x16x32_bf16 v[216:219], v[168:171], v[92:95], v[216:219]
    v_mfma_f32_16x16x32_bf16 v[224:227], v[168:171], v[96:99], v[224:227]
    v_mfma_f32_16x16x32_bf16 v[232:235], v[168:171], v[100:103], v[232:235]
    v_mfma_f32_16x16x32_bf16 v[220:223], v[172:175], v[92:95], v[220:223]
    v_mfma_f32_16x16x32_bf16 v[228:231], v[172:175], v[96:99], v[228:231]
    v_mfma_f32_16x16x32_bf16 v[236:239], v[172:175], v[100:103], v[236:239]
    v_mfma_f32_16x16x32_bf16 v[216:219], v[176:179], v[104:107], v[216:219]
    v_mfma_f32_16x16x32_bf16 v[224:227], v[176:179], v[108:111], v[224:227]
    v_mfma_f32_16x16x32_bf16 v[232:235], v[176:179], v[112:115], v[232:235]
    v_mfma_f32_16x16x32_bf16 v[220:223], v[180:183], v[104:107], v[220:223]
    v_mfma_f32_16x16x32_bf16 v[228:231], v[180:183], v[108:111], v[228:231]
    v_mfma_f32_16x16x32_bf16 v[236:239], v[180:183], v[112:115], v[236:239]
    v_mfma_f32_16x16x32_bf16 v[216:219], v[184:187], v[116:119], v[216:219]
    v_mfma_f32_16x16x32_bf16 v[224:227], v[184:187], v[120:123], v[224:227]
    v_mfma_f32_16x16x32_bf16 v[232:235], v[184:187], v[124:127], v[232:235]
    v_mfma_f32_16x16x32_bf16 v[220:223], v[188:191], v[116:119], v[220:223]
    v_mfma_f32_16x16x32_bf16 v[228:231], v[188:191], v[120:123], v[228:231]
    v_mfma_f32_16x16x32_bf16 v[236:239], v[188:191], v[124:127], v[236:239]
    s_nop 7
    v_cvt_pk_bf16_f32 v216, v216, v217
    v_cvt_pk_bf16_f32 v217, v218, v219
    v_cvt_pk_bf16_f32 v218, v220, v221
    v_cvt_pk_bf16_f32 v219, v222, v223
    v_cvt_pk_bf16_f32 v224, v224, v225
    v_cvt_pk_bf16_f32 v225, v226, v227
    v_cvt_pk_bf16_f32 v226, v228, v229
    v_cvt_pk_bf16_f32 v227, v230, v231
    v_cvt_pk_bf16_f32 v232, v232, v233
    v_cvt_pk_bf16_f32 v233, v234, v235
    v_cvt_pk_bf16_f32 v234, v236, v237
    v_cvt_pk_bf16_f32 v235, v238, v239
    s_add_u32 s32, s4, 3
    s_and_b32 s32, s32, 3
    s_mul_i32 s32, s32, 196608
    s_add_u32 s32, s32, s43
    buffer_store_dwordx4 v[216:219], v247, s[28:31], s32 offen offset:0 sc1
    buffer_store_dwordx4 v[224:227], v247, s[28:31], s32 offen offset:1024 sc1
    buffer_store_dwordx4 v[232:235], v247, s[28:31], s32 offen offset:2048 sc1
    s_mov_b32 s48, s84
    s_mov_b32 s49, s85
    s_mov_b32 s50, 0xc0000
    s_mov_b32 s51, 0x20000
    s_lshl_b32 s42, s38, 4
    s_add_u32 s42, s42, s5
    s_mul_i32 s42, s42, 49152
    s_cmp_ge_u32 s3, 3
    s_cselect_b32 s67, 1, 0
    s_mul_i32 s68, s67, 3
    s_sub_u32 s68, s3, s68
    v_lshlrev_b32_e64 v46, 4, v0
    s_lshl_b32 s64, s68, 10
    s_add_u32 s64, s64, s42
    s_mul_i32 s65, s67, 24576
    s_add_u32 s64, s64, s65
    s_lshl_b32 s66, s68, 11
    s_add_u32 s66, s66, 0
    v_lshlrev_b32 v47, 5, v0
    v_add_u32 v47, s66, v47
    s_and_b32 s65, s38, 7
    s_lshr_b32 s66, s38, 3
    s_mul_i32 s65, s65, 48
    s_lshl_b32 s68, s68, 4
    s_add_u32 s65, s65, s68
    s_lshl_b32 s65, s65, 11
    s_lshl_b32 s66, s66, 10
    s_add_u32 s65, s65, s66
    s_lshl_b32 s66, s5, 6
    s_add_u32 s65, s65, s66
    v_and_b32 v48, 15, v0
    v_lshrrev_b32 v49, 4, v0
    v_lshlrev_b32 v48, 11, v48
    v_lshl_add_u32 v48, v49, 3, v48
    s_mov_b32 s69, 0xffff0000
    v_mov_b32 v50, 0x2000
    s_waitcnt vmcnt(6)
    s_barrier
    s_waitcnt vmcnt(0)
    s_barrier
    s_branch L_REDUCE
L_LOADER:
    s_sub_u32 s93, s3, 4
    s_lshl_b32 s32, s5, 9
    s_add_u32 s12, s62, s32
    s_addc_u32 s13, s63, 0
    s_mov_b32 s14, 0x3fe200
    s_mov_b32 s15, 0x20000
    s_lshl_b32 s94, s93, 16
    v_lshrrev_b32 v1, 5, v0
    v_and_b32 v2, 31, v0
    v_lshlrev_b32 v3, 1, v1
    v_xor_b32 v2, v2, v3
    v_lshlrev_b32 v2, 4, v2
    s_and_b32 s33, s93, 1
    s_lshl_b32 s33, s33, 7
    v_xor_b32 v2, s33, v2
    v_lshl_add_u32 v2, v1, 13, v2
    v_add_u32 v10, 0x0, v2
    v_xor_b32 v11, 64, v2
    v_add_u32 v11, 0x3c00, v11
    v_add_u32 v12, 0x7800, v2
    v_xor_b32_e64 v13, 64, v2
    v_add_u32 v13, 0xb400, v13
    s_lshl_b32 s42, s4, 1
    s_lshl_b32 s37, s93, 12
    s_add_u32 s32, s42, 0
    s_and_b32 s32, s32, 15
    s_lshl_b32 s32, s32, 18
    s_add_u32 m0, s37, 0x0
    s_add_u32 s32, s32, s94
    buffer_load_dwordx4 v10, s[12:15], s32 offen offset:0  lds
    buffer_load_dwordx4 v11, s[12:15], s32 offen offset:1024  lds
    buffer_load_dwordx4 v12, s[12:15], s32 offen offset:2048  lds
    buffer_load_dwordx4 v13, s[12:15], s32 offen offset:3072  lds
    s_add_u32 s32, s42, 1
    s_and_b32 s32, s32, 15
    s_lshl_b32 s32, s32, 18
    s_add_u32 m0, s37, 0x4000
    s_add_u32 s32, s32, s94
    buffer_load_dwordx4 v10, s[12:15], s32 offen offset:0  lds
    buffer_load_dwordx4 v11, s[12:15], s32 offen offset:1024  lds
    buffer_load_dwordx4 v12, s[12:15], s32 offen offset:2048  lds
    buffer_load_dwordx4 v13, s[12:15], s32 offen offset:3072  lds
    s_add_u32 s32, s42, 2
    s_and_b32 s32, s32, 15
    s_lshl_b32 s32, s32, 18
    s_add_u32 m0, s37, 0x8000
    s_add_u32 s32, s32, s94
    buffer_load_dwordx4 v10, s[12:15], s32 offen offset:0  lds
    buffer_load_dwordx4 v11, s[12:15], s32 offen offset:1024  lds
    buffer_load_dwordx4 v12, s[12:15], s32 offen offset:2048  lds
    buffer_load_dwordx4 v13, s[12:15], s32 offen offset:3072  lds
    s_waitcnt vmcnt(8)
    s_barrier
    s_add_u32 s32, s42, 3
    s_and_b32 s32, s32, 15
    s_lshl_b32 s32, s32, 18
    s_add_u32 m0, s37, 0xc000
    s_add_u32 s32, s32, s94
    buffer_load_dwordx4 v10, s[12:15], s32 offen offset:0  lds
    buffer_load_dwordx4 v11, s[12:15], s32 offen offset:1024  lds
    buffer_load_dwordx4 v12, s[12:15], s32 offen offset:2048  lds
    buffer_load_dwordx4 v13, s[12:15], s32 offen offset:3072  lds
    s_add_u32 s32, s42, 4
    s_and_b32 s32, s32, 15
    s_lshl_b32 s32, s32, 18
    s_add_u32 m0, s37, 0x10000
    s_add_u32 s32, s32, s94
    buffer_load_dwordx4 v10, s[12:15], s32 offen offset:0  lds
    buffer_load_dwordx4 v11, s[12:15], s32 offen offset:1024  lds
    buffer_load_dwordx4 v12, s[12:15], s32 offen offset:2048  lds
    buffer_load_dwordx4 v13, s[12:15], s32 offen offset:3072  lds
    s_waitcnt vmcnt(12)
    s_barrier
    s_add_u32 s32, s42, 5
    s_and_b32 s32, s32, 15
    s_lshl_b32 s32, s32, 18
    s_add_u32 m0, s37, 0x14000
    s_add_u32 s32, s32, s94
    buffer_load_dwordx4 v10, s[12:15], s32 offen offset:0  lds
    buffer_load_dwordx4 v11, s[12:15], s32 offen offset:1024  lds
    buffer_load_dwordx4 v12, s[12:15], s32 offen offset:2048  lds
    buffer_load_dwordx4 v13, s[12:15], s32 offen offset:3072  lds
    s_add_u32 s32, s42, 6
    s_and_b32 s32, s32, 15
    s_lshl_b32 s32, s32, 18
    s_add_u32 m0, s37, 0x18000
    s_add_u32 s32, s32, s94
    buffer_load_dwordx4 v10, s[12:15], s32 offen offset:0  lds
    buffer_load_dwordx4 v11, s[12:15], s32 offen offset:1024  lds
    buffer_load_dwordx4 v12, s[12:15], s32 offen offset:2048  lds
    buffer_load_dwordx4 v13, s[12:15], s32 offen offset:3072  lds
    s_waitcnt vmcnt(16)
    s_barrier
    s_add_u32 s32, s42, 7
    s_and_b32 s32, s32, 15
    s_lshl_b32 s32, s32, 18
    s_add_u32 m0, s37, 0x0
    s_add_u32 s32, s32, s94
    buffer_load_dwordx4 v10, s[12:15], s32 offen offset:0  lds
    buffer_load_dwordx4 v11, s[12:15], s32 offen offset:1024  lds
    buffer_load_dwordx4 v12, s[12:15], s32 offen offset:2048  lds
    buffer_load_dwordx4 v13, s[12:15], s32 offen offset:3072  lds
    s_add_u32 s32, s42, 8
    s_and_b32 s32, s32, 15
    s_lshl_b32 s32, s32, 18
    s_add_u32 m0, s37, 0x4000
    s_add_u32 s32, s32, s94
    buffer_load_dwordx4 v10, s[12:15], s32 offen offset:0  lds
    buffer_load_dwordx4 v11, s[12:15], s32 offen offset:1024  lds
    buffer_load_dwordx4 v12, s[12:15], s32 offen offset:2048  lds
    buffer_load_dwordx4 v13, s[12:15], s32 offen offset:3072  lds
    s_lshl_b32 s32, s4, 3
    s_add_u32 s32, s32, s7
    s_lshl_b32 s32, s32, 18
    s_add_u32 s16, s58, s32
    s_addc_u32 s17, s59, 0
    s_mov_b32 s18, 0x40000
    s_mov_b32 s19, 0x20000
    s_add_u32 s20, s60, s32
    s_addc_u32 s21, s61, 0
    s_mov_b32 s22, 0x40000
    s_mov_b32 s23, 0x20000
    s_lshl_b32 s32, s5, 18
    s_add_u32 s24, s90, s32
    s_addc_u32 s25, s91, 0
    s_mov_b32 s26, 0x40000
    s_mov_b32 s27, 0x20000
    s_lshl_b32 s95, s93, 11
    s_lshl_b32 s70, s4, 3
    s_add_u32 s70, s70, s7
    s_mul_i32 s70, s70, 1
    s_mul_i32 s33, s6, 16
    s_add_u32 s70, s70, s33
    s_and_b32 s70, s70, 31
    s_lshl_b32 s70, s70, 13
    v_lshrrev_b32 v1, 4, v0
    v_and_b32 v2, 15, v0
    v_xor_b32 v3, v2, v1
    s_and_b32 s33, s93, 1
    s_lshl_b32 s33, s33, 3
    v_xor_b32 v3, s33, v3
    v_lshlrev_b32_e64 v3, 4, v3
    v_lshl_add_u32 v14, v1, 8, v3
    v_xor_b32 v15, 64, v14
    v_lshlrev_b32 v3, 2, v1
    v_xor_b32 v3, v2, v3
    v_lshlrev_b32 v3, 4, v3
    v_lshl_add_u32 v16, v1, 8, v3
    v_lshrrev_b32 v1, 4, v0
    v_and_b32 v2, 15, v0
    v_lshlrev_b32 v3, 1, v1
    v_xor_b32 v2, v2, v3
    v_lshlrev_b32_e64 v2, 4, v2
    v_lshl_add_u32 v2, v1, 10, v2
    v_add_u32_e64 v18, 0, v2
    v_add_u32 v19, 3072, v2
    v_xor_b32 v20, 128, v2
    v_add_u32 v20, 6144, v20
    v_xor_b32 v21, 128, v2
    v_add_u32 v21, 9216, v21
    s_waitcnt vmcnt(20)
    s_barrier
    s_add_u32 s32, s42, 9
    s_and_b32 s32, s32, 15
    s_lshl_b32 s32, s32, 18
    s_add_u32 m0, s37, 0x8000
    s_add_u32 s32, s32, s94
    buffer_load_dwordx4 v10, s[12:15], s32 offen offset:0  lds
    buffer_load_dwordx4 v11, s[12:15], s32 offen offset:1024  lds
    buffer_load_dwordx4 v12, s[12:15], s32 offen offset:2048  lds
    buffer_load_dwordx4 v13, s[12:15], s32 offen offset:3072  lds
    s_waitcnt vmcnt(20)
    s_barrier
    s_add_u32 s32, s42, 10
    s_and_b32 s32, s32, 15
    s_lshl_b32 s32, s32, 18
    s_add_u32 m0, s37, 0xc000
    s_add_u32 s32, s32, s94
    buffer_load_dwordx4 v10, s[12:15], s32 offen offset:0  lds
    buffer_load_dwordx4 v11, s[12:15], s32 offen offset:1024  lds
    buffer_load_dwordx4 v12, s[12:15], s32 offen offset:2048  lds
    buffer_load_dwordx4 v13, s[12:15], s32 offen offset:3072  lds
    s_waitcnt vmcnt(20)
    s_barrier
    s_add_u32 s32, s42, 11
    s_and_b32 s32, s32, 15
    s_lshl_b32 s32, s32, 18
    s_add_u32 m0, s37, 0x10000
    s_add_u32 s32, s32, s94
    buffer_load_dwordx4 v10, s[12:15], s32 offen offset:0  lds
    buffer_load_dwordx4 v11, s[12:15], s32 offen offset:1024  lds
    buffer_load_dwordx4 v12, s[12:15], s32 offen offset:2048  lds
    buffer_load_dwordx4 v13, s[12:15], s32 offen offset:3072  lds
    s_waitcnt vmcnt(20)
    s_barrier
    s_add_u32 s32, s42, 12
    s_and_b32 s32, s32, 15
    s_lshl_b32 s32, s32, 18
    s_add_u32 m0, s37, 0x14000
    s_add_u32 s32, s32, s94
    buffer_load_dwordx4 v10, s[12:15], s32 offen offset:0  lds
    buffer_load_dwordx4 v11, s[12:15], s32 offen offset:1024  lds
    buffer_load_dwordx4 v12, s[12:15], s32 offen offset:2048  lds
    buffer_load_dwordx4 v13, s[12:15], s32 offen offset:3072  lds
    s_waitcnt vmcnt(20)
    s_barrier
    s_add_u32 s32, s42, 13
    s_and_b32 s32, s32, 15
    s_lshl_b32 s32, s32, 18
    s_add_u32 m0, s37, 0x18000
    s_add_u32 s32, s32, s94
    buffer_load_dwordx4 v10, s[12:15], s32 offen offset:0  lds
    buffer_load_dwordx4 v11, s[12:15], s32 offen offset:1024  lds
    buffer_load_dwordx4 v12, s[12:15], s32 offen offset:2048  lds
    buffer_load_dwordx4 v13, s[12:15], s32 offen offset:3072  lds
    s_waitcnt vmcnt(20)
    s_barrier
    s_add_u32 s32, s42, 14
    s_and_b32 s32, s32, 15
    s_lshl_b32 s32, s32, 18
    s_add_u32 m0, s37, 0x0
    s_add_u32 s32, s32, s94
    buffer_load_dwordx4 v10, s[12:15], s32 offen offset:0  lds
    buffer_load_dwordx4 v11, s[12:15], s32 offen offset:1024  lds
    buffer_load_dwordx4 v12, s[12:15], s32 offen offset:2048  lds
    buffer_load_dwordx4 v13, s[12:15], s32 offen offset:3072  lds
    s_waitcnt vmcnt(20)
    s_barrier
    s_add_u32 s32, s42, 15
    s_and_b32 s32, s32, 15
    s_lshl_b32 s32, s32, 18
    s_add_u32 m0, s37, 0x4000
    s_add_u32 s32, s32, s94
    buffer_load_dwordx4 v10, s[12:15], s32 offen offset:0  lds
    buffer_load_dwordx4 v11, s[12:15], s32 offen offset:1024  lds
    buffer_load_dwordx4 v12, s[12:15], s32 offen offset:2048  lds
    buffer_load_dwordx4 v13, s[12:15], s32 offen offset:3072  lds
    s_waitcnt vmcnt(20)
    s_barrier
    s_add_u32 s39, s70, 0x0
    s_and_b32 s39, s39, 0x3ffff
    s_add_u32 m0, s95, 0x8000
    s_add_u32 s39, s39, s95
    buffer_load_dwordx4 v14, s[16:19], s39 offen offset:0 nt lds
    buffer_load_dwordx4 v15, s[16:19], s39 offen offset:1024 nt lds
    s_waitcnt vmcnt(18)
    s_barrier
    s_add_u32 s39, s70, 0x2000
    s_and_b32 s39, s39, 0x3ffff
    s_add_u32 m0, s95, 0xa000
    s_add_u32 s39, s39, s95
    buffer_load_dwordx4 v14, s[16:19], s39 offen offset:0 nt lds
    buffer_load_dwordx4 v15, s[16:19], s39 offen offset:1024 nt lds
    s_waitcnt vmcnt(16)
    s_barrier
    s_add_u32 s39, s70, 0x0
    s_and_b32 s39, s39, 0x3ffff
    s_add_u32 m0, s95, 0x10000
    s_add_u32 s39, s39, s95
    buffer_load_dwordx4 v16, s[20:23], s39 offen offset:0 nt lds
    buffer_load_dwordx4 v16, s[20:23], s39 offen offset:1024 nt lds
    s_waitcnt vmcnt(14)
    s_barrier
    s_add_u32 s39, s70, 0x4000
    s_and_b32 s39, s39, 0x3ffff
    s_add_u32 m0, s95, 0xc000
    s_add_u32 s39, s39, s95
    buffer_load_dwordx4 v14, s[16:19], s39 offen offset:0 nt lds
    buffer_load_dwordx4 v15, s[16:19], s39 offen offset:1024 nt lds
    s_waitcnt vmcnt(12)
    s_barrier
    s_add_u32 s39, s70, 0x2000
    s_and_b32 s39, s39, 0x3ffff
    s_add_u32 m0, s95, 0x12000
    s_add_u32 s39, s39, s95
    buffer_load_dwordx4 v16, s[20:23], s39 offen offset:0 nt lds
    buffer_load_dwordx4 v16, s[20:23], s39 offen offset:1024 nt lds
    s_waitcnt vmcnt(10)
    s_barrier
    s_add_u32 s39, s70, 0x6000
    s_and_b32 s39, s39, 0x3ffff
    s_add_u32 m0, s95, 0xe000
    s_add_u32 s39, s39, s95
    buffer_load_dwordx4 v14, s[16:19], s39 offen offset:0 nt lds
    buffer_load_dwordx4 v15, s[16:19], s39 offen offset:1024 nt lds
    s_barrier
    s_add_u32 s39, s70, 0x4000
    s_and_b32 s39, s39, 0x3ffff
    s_add_u32 m0, s95, 0x14000
    s_add_u32 s39, s39, s95
    buffer_load_dwordx4 v16, s[20:23], s39 offen offset:0 nt lds
    buffer_load_dwordx4 v16, s[20:23], s39 offen offset:1024 nt lds
    s_waitcnt vmcnt(12)
    s_barrier
    s_add_u32 s39, s70, 0x8000
    s_and_b32 s39, s39, 0x3ffff
    s_add_u32 m0, s95, 0x0
    s_add_u32 s39, s39, s95
    buffer_load_dwordx4 v14, s[16:19], s39 offen offset:0 nt lds
    buffer_load_dwordx4 v15, s[16:19], s39 offen offset:1024 nt lds
    s_add_u32 s39, s70, 0x6000
    s_and_b32 s39, s39, 0x3ffff
    s_add_u32 m0, s95, 0x16000
    s_add_u32 s39, s39, s95
    buffer_load_dwordx4 v16, s[20:23], s39 offen offset:0 nt lds
    buffer_load_dwordx4 v16, s[20:23], s39 offen offset:1024 nt lds
    s_add_u32 s39, s70, 0xa000
    s_and_b32 s39, s39, 0x3ffff
    s_add_u32 m0, s95, 0x2000
    s_add_u32 s39, s39, s95
    buffer_load_dwordx4 v14, s[16:19], s39 offen offset:0 nt lds
    buffer_load_dwordx4 v15, s[16:19], s39 offen offset:1024 nt lds
    s_mov_b32 s28, s88
    s_mov_b32 s29, s89
    s_mov_b32 s30, 0x10000000
    s_mov_b32 s31, 0x20000
    s_mov_b32 s96, s86
    s_mov_b32 s97, s87
    s_mov_b32 s98, 0x100
    s_mov_b32 s99, 0x20000
    s_lshl_b32 s32, s38, 4
    v_mov_b32_e64 v2, s32
    s_waitcnt vmcnt(16)
    s_barrier
    s_add_u32 s39, s70, 0xc000
    s_and_b32 s39, s39, 0x3ffff
    s_add_u32 m0, s95, 0x4000
    s_add_u32 s39, s39, s95
    buffer_load_dwordx4 v14, s[16:19], s39 offen offset:0 nt lds
    buffer_load_dwordx4 v15, s[16:19], s39 offen offset:1024 nt lds
    s_add_u32 s39, s70, 0x8000
    s_and_b32 s39, s39, 0x3ffff
    s_add_u32 m0, s95, 0x18000
    s_add_u32 s39, s39, s95
    buffer_load_dwordx4 v16, s[20:23], s39 offen offset:0 nt lds
    buffer_load_dwordx4 v16, s[20:23], s39 offen offset:1024 nt lds
    s_waitcnt vmcnt(16)
    s_barrier
    s_add_u32 s39, s70, 0xe000
    s_and_b32 s39, s39, 0x3ffff
    s_add_u32 m0, s95, 0x6000
    s_add_u32 s39, s39, s95
    buffer_load_dwordx4 v14, s[16:19], s39 offen offset:0 nt lds
    buffer_load_dwordx4 v15, s[16:19], s39 offen offset:1024 nt lds
    s_add_u32 s39, s70, 0xa000
    s_and_b32 s39, s39, 0x3ffff
    s_add_u32 m0, s95, 0x1a000
    s_add_u32 s39, s39, s95
    buffer_load_dwordx4 v16, s[20:23], s39 offen offset:0 nt lds
    buffer_load_dwordx4 v16, s[20:23], s39 offen offset:1024 nt lds
    s_waitcnt vmcnt(16)
    s_barrier
    s_add_u32 s39, s70, 0x10000
    s_and_b32 s39, s39, 0x3ffff
    s_add_u32 m0, s95, 0x8000
    s_add_u32 s39, s39, s95
    buffer_load_dwordx4 v14, s[16:19], s39 offen offset:0 nt lds
    buffer_load_dwordx4 v15, s[16:19], s39 offen offset:1024 nt lds
    s_add_u32 s39, s70, 0xc000
    s_and_b32 s39, s39, 0x3ffff
    s_add_u32 m0, s95, 0x1c000
    s_add_u32 s39, s39, s95
    buffer_load_dwordx4 v16, s[20:23], s39 offen offset:0 nt lds
    buffer_load_dwordx4 v16, s[20:23], s39 offen offset:1024 nt lds
    s_waitcnt vmcnt(16)
    s_barrier
    s_add_u32 s39, s70, 0x12000
    s_and_b32 s39, s39, 0x3ffff
    s_add_u32 m0, s95, 0xa000
    s_add_u32 s39, s39, s95
    buffer_load_dwordx4 v14, s[16:19], s39 offen offset:0 nt lds
    buffer_load_dwordx4 v15, s[16:19], s39 offen offset:1024 nt lds
    s_add_u32 s39, s70, 0xe000
    s_and_b32 s39, s39, 0x3ffff
    s_add_u32 m0, s95, 0x1e000
    s_add_u32 s39, s39, s95
    buffer_load_dwordx4 v16, s[20:23], s39 offen offset:0 nt lds
    buffer_load_dwordx4 v16, s[20:23], s39 offen offset:1024 nt lds
    buffer_load_dword v243, v2, s[96:99], 0 offen sc1
    s_waitcnt vmcnt(17)
    s_barrier
    s_add_u32 s39, s70, 0x14000
    s_and_b32 s39, s39, 0x3ffff
    s_add_u32 m0, s95, 0xc000
    s_add_u32 s39, s39, s95
    buffer_load_dwordx4 v14, s[16:19], s39 offen offset:0 nt lds
    buffer_load_dwordx4 v15, s[16:19], s39 offen offset:1024 nt lds
    s_add_u32 s39, s70, 0x10000
    s_and_b32 s39, s39, 0x3ffff
    s_add_u32 m0, s95, 0x10000
    s_add_u32 s39, s39, s95
    buffer_load_dwordx4 v16, s[20:23], s39 offen offset:0 nt lds
    buffer_load_dwordx4 v16, s[20:23], s39 offen offset:1024 nt lds
    s_waitcnt vmcnt(17)
    s_barrier
    s_add_u32 s39, s70, 0x16000
    s_and_b32 s39, s39, 0x3ffff
    s_add_u32 m0, s95, 0xe000
    s_add_u32 s39, s39, s95
    buffer_load_dwordx4 v14, s[16:19], s39 offen offset:0 nt lds
    buffer_load_dwordx4 v15, s[16:19], s39 offen offset:1024 nt lds
    s_add_u32 s39, s70, 0x12000
    s_and_b32 s39, s39, 0x3ffff
    s_add_u32 m0, s95, 0x12000
    s_add_u32 s39, s39, s95
    buffer_load_dwordx4 v16, s[20:23], s39 offen offset:0 nt lds
    buffer_load_dwordx4 v16, s[20:23], s39 offen offset:1024 nt lds
    s_waitcnt vmcnt(17)
    s_barrier
    s_add_u32 s39, s70, 0x18000
    s_and_b32 s39, s39, 0x3ffff
    s_add_u32 m0, s95, 0x0
    s_add_u32 s39, s39, s95
    buffer_load_dwordx4 v14, s[16:19], s39 offen offset:0 nt lds
    buffer_load_dwordx4 v15, s[16:19], s39 offen offset:1024 nt lds
    s_add_u32 s39, s70, 0x14000
    s_and_b32 s39, s39, 0x3ffff
    s_add_u32 m0, s95, 0x14000
    s_add_u32 s39, s39, s95
    buffer_load_dwordx4 v16, s[20:23], s39 offen offset:0 nt lds
    buffer_load_dwordx4 v16, s[20:23], s39 offen offset:1024 nt lds
    s_waitcnt vmcnt(17)
    s_barrier
    s_add_u32 s39, s70, 0x1a000
    s_and_b32 s39, s39, 0x3ffff
    s_add_u32 m0, s95, 0x2000
    s_add_u32 s39, s39, s95
    buffer_load_dwordx4 v14, s[16:19], s39 offen offset:0 nt lds
    buffer_load_dwordx4 v15, s[16:19], s39 offen offset:1024 nt lds
    s_add_u32 s39, s70, 0x16000
    s_and_b32 s39, s39, 0x3ffff
    s_add_u32 m0, s95, 0x16000
    s_add_u32 s39, s39, s95
    buffer_load_dwordx4 v16, s[20:23], s39 offen offset:0 nt lds
    buffer_load_dwordx4 v16, s[20:23], s39 offen offset:1024 nt lds
    s_waitcnt vmcnt(17)
    s_barrier
    s_add_u32 s39, s70, 0x1c000
    s_and_b32 s39, s39, 0x3ffff
    s_add_u32 m0, s95, 0x4000
    s_add_u32 s39, s39, s95
    buffer_load_dwordx4 v14, s[16:19], s39 offen offset:0 nt lds
    buffer_load_dwordx4 v15, s[16:19], s39 offen offset:1024 nt lds
    s_add_u32 s39, s70, 0x18000
    s_and_b32 s39, s39, 0x3ffff
    s_add_u32 m0, s95, 0x18000
    s_add_u32 s39, s39, s95
    buffer_load_dwordx4 v16, s[20:23], s39 offen offset:0 nt lds
    buffer_load_dwordx4 v16, s[20:23], s39 offen offset:1024 nt lds
    s_waitcnt vmcnt(16)
    s_barrier
    s_add_u32 s39, s70, 0x1e000
    s_and_b32 s39, s39, 0x3ffff
    s_add_u32 m0, s95, 0x6000
    s_add_u32 s39, s39, s95
    buffer_load_dwordx4 v14, s[16:19], s39 offen offset:0 nt lds
    buffer_load_dwordx4 v15, s[16:19], s39 offen offset:1024 nt lds
    s_add_u32 s39, s70, 0x1a000
    s_and_b32 s39, s39, 0x3ffff
    s_add_u32 m0, s95, 0x1a000
    s_add_u32 s39, s39, s95
    buffer_load_dwordx4 v16, s[20:23], s39 offen offset:0 nt lds
    buffer_load_dwordx4 v16, s[20:23], s39 offen offset:1024 nt lds
    s_waitcnt vmcnt(16)
    s_barrier
    s_add_u32 s39, s70, 0x20000
    s_and_b32 s39, s39, 0x3ffff
    s_add_u32 m0, s95, 0x8000
    s_add_u32 s39, s39, s95
    buffer_load_dwordx4 v14, s[16:19], s39 offen offset:0 nt lds
    buffer_load_dwordx4 v15, s[16:19], s39 offen offset:1024 nt lds
    s_add_u32 s39, s70, 0x1c000
    s_and_b32 s39, s39, 0x3ffff
    s_add_u32 m0, s95, 0x1c000
    s_add_u32 s39, s39, s95
    buffer_load_dwordx4 v16, s[20:23], s39 offen offset:0 nt lds
    buffer_load_dwordx4 v16, s[20:23], s39 offen offset:1024 nt lds
    s_waitcnt vmcnt(16)
    s_barrier
    s_add_u32 s39, s70, 0x22000
    s_and_b32 s39, s39, 0x3ffff
    s_add_u32 m0, s95, 0xa000
    s_add_u32 s39, s39, s95
    buffer_load_dwordx4 v14, s[16:19], s39 offen offset:0 nt lds
    buffer_load_dwordx4 v15, s[16:19], s39 offen offset:1024 nt lds
    s_add_u32 s39, s70, 0x1e000
    s_and_b32 s39, s39, 0x3ffff
    s_add_u32 m0, s95, 0x1e000
    s_add_u32 s39, s39, s95
    buffer_load_dwordx4 v16, s[20:23], s39 offen offset:0 nt lds
    buffer_load_dwordx4 v16, s[20:23], s39 offen offset:1024 nt lds
    s_waitcnt vmcnt(16)
    s_barrier
    s_add_u32 s39, s70, 0x24000
    s_and_b32 s39, s39, 0x3ffff
    s_add_u32 m0, s95, 0xc000
    s_add_u32 s39, s39, s95
    buffer_load_dwordx4 v14, s[16:19], s39 offen offset:0 nt lds
    buffer_load_dwordx4 v15, s[16:19], s39 offen offset:1024 nt lds
    s_add_u32 s39, s70, 0x20000
    s_and_b32 s39, s39, 0x3ffff
    s_add_u32 m0, s95, 0x10000
    s_add_u32 s39, s39, s95
    buffer_load_dwordx4 v16, s[20:23], s39 offen offset:0 nt lds
    buffer_load_dwordx4 v16, s[20:23], s39 offen offset:1024 nt lds
    s_waitcnt vmcnt(16)
    s_barrier
    s_add_u32 s39, s70, 0x26000
    s_and_b32 s39, s39, 0x3ffff
    s_add_u32 m0, s95, 0xe000
    s_add_u32 s39, s39, s95
    buffer_load_dwordx4 v14, s[16:19], s39 offen offset:0 nt lds
    buffer_load_dwordx4 v15, s[16:19], s39 offen offset:1024 nt lds
    s_add_u32 s39, s70, 0x22000
    s_and_b32 s39, s39, 0x3ffff
    s_add_u32 m0, s95, 0x12000
    s_add_u32 s39, s39, s95
    buffer_load_dwordx4 v16, s[20:23], s39 offen offset:0 nt lds
    buffer_load_dwordx4 v16, s[20:23], s39 offen offset:1024 nt lds
    s_waitcnt vmcnt(16)
    s_barrier
    s_add_u32 s39, s70, 0x28000
    s_and_b32 s39, s39, 0x3ffff
    s_add_u32 m0, s95, 0x0
    s_add_u32 s39, s39, s95
    buffer_load_dwordx4 v14, s[16:19], s39 offen offset:0 nt lds
    buffer_load_dwordx4 v15, s[16:19], s39 offen offset:1024 nt lds
    s_add_u32 s39, s70, 0x24000
    s_and_b32 s39, s39, 0x3ffff
    s_add_u32 m0, s95, 0x14000
    s_add_u32 s39, s39, s95
    buffer_load_dwordx4 v16, s[20:23], s39 offen offset:0 nt lds
    buffer_load_dwordx4 v16, s[20:23], s39 offen offset:1024 nt lds
    s_waitcnt vmcnt(16)
    s_barrier
    s_add_u32 s39, s70, 0x2a000
    s_and_b32 s39, s39, 0x3ffff
    s_add_u32 m0, s95, 0x2000
    s_add_u32 s39, s39, s95
    buffer_load_dwordx4 v14, s[16:19], s39 offen offset:0 nt lds
    buffer_load_dwordx4 v15, s[16:19], s39 offen offset:1024 nt lds
    s_add_u32 s39, s70, 0x26000
    s_and_b32 s39, s39, 0x3ffff
    s_add_u32 m0, s95, 0x16000
    s_add_u32 s39, s39, s95
    buffer_load_dwordx4 v16, s[20:23], s39 offen offset:0 nt lds
    buffer_load_dwordx4 v16, s[20:23], s39 offen offset:1024 nt lds
    s_mov_b32 s36, 0
L_FLAG_CHECK:
    v_readfirstlane_b32 s33, v243
    s_add_u32 s36, s36, 1
    s_cmp_lg_u32 s33, 0
    s_cbranch_scc1 L_FLAG_OK
    s_cmp_ge_u32 s36, 0x100000
    s_cbranch_scc1 L_FLAG_OK
    s_sleep 8
    buffer_load_dword v243, v2, s[96:99], 0 offen sc1
    s_waitcnt vmcnt(0)
    s_branch L_FLAG_CHECK
L_FLAG_OK:
    s_waitcnt vmcnt(16)
    s_barrier
    s_add_u32 s39, s70, 0x2c000
    s_and_b32 s39, s39, 0x3ffff
    s_add_u32 m0, s95, 0x4000
    s_add_u32 s39, s39, s95
    buffer_load_dwordx4 v14, s[16:19], s39 offen offset:0 nt lds
    buffer_load_dwordx4 v15, s[16:19], s39 offen offset:1024 nt lds
    s_add_u32 s39, s70, 0x28000
    s_and_b32 s39, s39, 0x3ffff
    s_add_u32 m0, s95, 0x18000
    s_add_u32 s39, s39, s95
    buffer_load_dwordx4 v16, s[20:23], s39 offen offset:0 nt lds
    buffer_load_dwordx4 v16, s[20:23], s39 offen offset:1024 nt lds
    s_waitcnt vmcnt(16)
    s_barrier
    s_add_u32 s39, s70, 0x2e000
    s_and_b32 s39, s39, 0x3ffff
    s_add_u32 m0, s95, 0x6000
    s_add_u32 s39, s39, s95
    buffer_load_dwordx4 v14, s[16:19], s39 offen offset:0 nt lds
    buffer_load_dwordx4 v15, s[16:19], s39 offen offset:1024 nt lds
    s_add_u32 s39, s70, 0x2a000
    s_and_b32 s39, s39, 0x3ffff
    s_add_u32 m0, s95, 0x1a000
    s_add_u32 s39, s39, s95
    buffer_load_dwordx4 v16, s[20:23], s39 offen offset:0 nt lds
    buffer_load_dwordx4 v16, s[20:23], s39 offen offset:1024 nt lds
    s_waitcnt vmcnt(16)
    s_barrier
    s_add_u32 s39, s70, 0x30000
    s_and_b32 s39, s39, 0x3ffff
    s_add_u32 m0, s95, 0x8000
    s_add_u32 s39, s39, s95
    buffer_load_dwordx4 v14, s[16:19], s39 offen offset:0 nt lds
    buffer_load_dwordx4 v15, s[16:19], s39 offen offset:1024 nt lds
    s_add_u32 s39, s70, 0x2c000
    s_and_b32 s39, s39, 0x3ffff
    s_add_u32 m0, s95, 0x1c000
    s_add_u32 s39, s39, s95
    buffer_load_dwordx4 v16, s[20:23], s39 offen offset:0 nt lds
    buffer_load_dwordx4 v16, s[20:23], s39 offen offset:1024 nt lds
    s_waitcnt vmcnt(16)
    s_barrier
    s_add_u32 s39, s70, 0x32000
    s_and_b32 s39, s39, 0x3ffff
    s_add_u32 m0, s95, 0xa000
    s_add_u32 s39, s39, s95
    buffer_load_dwordx4 v14, s[16:19], s39 offen offset:0 nt lds
    buffer_load_dwordx4 v15, s[16:19], s39 offen offset:1024 nt lds
    s_add_u32 s39, s70, 0x2e000
    s_and_b32 s39, s39, 0x3ffff
    s_add_u32 m0, s95, 0x1e000
    s_add_u32 s39, s39, s95
    buffer_load_dwordx4 v16, s[20:23], s39 offen offset:0 nt lds
    buffer_load_dwordx4 v16, s[20:23], s39 offen offset:1024 nt lds
    s_waitcnt vmcnt(16)
    s_barrier
    s_add_u32 s39, s70, 0x34000
    s_and_b32 s39, s39, 0x3ffff
    s_add_u32 m0, s95, 0xc000
    s_add_u32 s39, s39, s95
    buffer_load_dwordx4 v14, s[16:19], s39 offen offset:0 nt lds
    buffer_load_dwordx4 v15, s[16:19], s39 offen offset:1024 nt lds
    s_add_u32 s39, s70, 0x30000
    s_and_b32 s39, s39, 0x3ffff
    s_add_u32 m0, s95, 0x10000
    s_add_u32 s39, s39, s95
    buffer_load_dwordx4 v16, s[20:23], s39 offen offset:0 nt lds
    buffer_load_dwordx4 v16, s[20:23], s39 offen offset:1024 nt lds
    s_waitcnt vmcnt(16)
    s_barrier
    s_add_u32 s39, s70, 0x36000
    s_and_b32 s39, s39, 0x3ffff
    s_add_u32 m0, s95, 0xe000
    s_add_u32 s39, s39, s95
    buffer_load_dwordx4 v14, s[16:19], s39 offen offset:0 nt lds
    buffer_load_dwordx4 v15, s[16:19], s39 offen offset:1024 nt lds
    s_add_u32 s39, s70, 0x32000
    s_and_b32 s39, s39, 0x3ffff
    s_add_u32 m0, s95, 0x12000
    s_add_u32 s39, s39, s95
    buffer_load_dwordx4 v16, s[20:23], s39 offen offset:0 nt lds
    buffer_load_dwordx4 v16, s[20:23], s39 offen offset:1024 nt lds
    s_waitcnt vmcnt(16)
    s_barrier
    s_add_u32 s39, s70, 0x38000
    s_and_b32 s39, s39, 0x3ffff
    s_add_u32 m0, s95, 0x0
    s_add_u32 s39, s39, s95
    buffer_load_dwordx4 v14, s[16:19], s39 offen offset:0 nt lds
    buffer_load_dwordx4 v15, s[16:19], s39 offen offset:1024 nt lds
    s_add_u32 s39, s70, 0x34000
    s_and_b32 s39, s39, 0x3ffff
    s_add_u32 m0, s95, 0x14000
    s_add_u32 s39, s39, s95
    buffer_load_dwordx4 v16, s[20:23], s39 offen offset:0 nt lds
    buffer_load_dwordx4 v16, s[20:23], s39 offen offset:1024 nt lds
    s_waitcnt vmcnt(16)
    s_barrier
    s_add_u32 s39, s70, 0x3a000
    s_and_b32 s39, s39, 0x3ffff
    s_add_u32 m0, s95, 0x2000
    s_add_u32 s39, s39, s95
    buffer_load_dwordx4 v14, s[16:19], s39 offen offset:0 nt lds
    buffer_load_dwordx4 v15, s[16:19], s39 offen offset:1024 nt lds
    s_add_u32 s39, s70, 0x36000
    s_and_b32 s39, s39, 0x3ffff
    s_add_u32 m0, s95, 0x16000
    s_add_u32 s39, s39, s95
    buffer_load_dwordx4 v16, s[20:23], s39 offen offset:0 nt lds
    buffer_load_dwordx4 v16, s[20:23], s39 offen offset:1024 nt lds
    s_waitcnt vmcnt(16)
    s_barrier
    s_add_u32 s39, s70, 0x3c000
    s_and_b32 s39, s39, 0x3ffff
    s_add_u32 m0, s95, 0x4000
    s_add_u32 s39, s39, s95
    buffer_load_dwordx4 v14, s[16:19], s39 offen offset:0 nt lds
    buffer_load_dwordx4 v15, s[16:19], s39 offen offset:1024 nt lds
    s_add_u32 s39, s70, 0x38000
    s_and_b32 s39, s39, 0x3ffff
    s_add_u32 m0, s95, 0x18000
    s_add_u32 s39, s39, s95
    buffer_load_dwordx4 v16, s[20:23], s39 offen offset:0 nt lds
    buffer_load_dwordx4 v16, s[20:23], s39 offen offset:1024 nt lds
    s_waitcnt vmcnt(16)
    s_barrier
    s_add_u32 s39, s70, 0x3e000
    s_and_b32 s39, s39, 0x3ffff
    s_add_u32 m0, s95, 0x6000
    s_add_u32 s39, s39, s95
    buffer_load_dwordx4 v14, s[16:19], s39 offen offset:0 nt lds
    buffer_load_dwordx4 v15, s[16:19], s39 offen offset:1024 nt lds
    s_add_u32 s39, s70, 0x3a000
    s_and_b32 s39, s39, 0x3ffff
    s_add_u32 m0, s95, 0x1a000
    s_add_u32 s39, s39, s95
    buffer_load_dwordx4 v16, s[20:23], s39 offen offset:0 nt lds
    buffer_load_dwordx4 v16, s[20:23], s39 offen offset:1024 nt lds
    s_waitcnt vmcnt(16)
    s_barrier
    s_add_u32 s39, s70, 0x3c000
    s_and_b32 s39, s39, 0x3ffff
    s_add_u32 m0, s95, 0x1c000
    s_add_u32 s39, s39, s95
    buffer_load_dwordx4 v16, s[20:23], s39 offen offset:0 nt lds
    buffer_load_dwordx4 v16, s[20:23], s39 offen offset:1024 nt lds
    s_waitcnt vmcnt(14)
    s_barrier
    s_add_u32 s39, s70, 0x3e000
    s_and_b32 s39, s39, 0x3ffff
    s_add_u32 m0, s95, 0x1e000
    s_add_u32 s39, s39, s95
    buffer_load_dwordx4 v16, s[20:23], s39 offen offset:0 nt lds
    buffer_load_dwordx4 v16, s[20:23], s39 offen offset:1024 nt lds
    s_add_u32 s32, s4, 0
    s_and_b32 s32, s32, 3
    s_lshl_b32 s32, s32, 8
    s_lshl_b32 s33, s37, 3
    s_add_u32 s32, s32, s33
    s_lshl_b32 s33, s37, 1
    s_add_u32 m0, s33, 0x8000
    s_nop 0
    buffer_load_dwordx4 v18, s[24:27], s32 offen offset:0  lds
    buffer_load_dwordx4 v19, s[24:27], s32 offen offset:1024  lds
    buffer_load_dwordx4 v20, s[24:27], s32 offen offset:2048  lds
    buffer_load_dwordx4 v21, s[24:27], s32 offen offset:3072  lds
    s_add_u32 m0, s33, 0x9000
    s_add_u32 s32, s32, 16384
    buffer_load_dwordx4 v18, s[24:27], s32 offen offset:0  lds
    buffer_load_dwordx4 v19, s[24:27], s32 offen offset:1024  lds
    buffer_load_dwordx4 v20, s[24:27], s32 offen offset:2048  lds
    buffer_load_dwordx4 v21, s[24:27], s32 offen offset:3072  lds
    s_waitcnt vmcnt(20)
    s_barrier
    s_waitcnt vmcnt(16)
    s_barrier
    s_waitcnt vmcnt(12)
    s_barrier
    s_add_u32 s32, s4, 0
    s_and_b32 s32, s32, 3
    s_lshl_b32 s32, s32, 8
    s_lshl_b32 s33, s37, 3
    s_add_u32 s32, s32, s33
    s_add_u32 s32, s32, 0x20000
    s_lshl_b32 s33, s37, 1
    s_add_u32 m0, s33, 0x10000
    s_nop 0
    buffer_load_dwordx4 v18, s[24:27], s32 offen offset:0  lds
    buffer_load_dwordx4 v19, s[24:27], s32 offen offset:1024  lds
    buffer_load_dwordx4 v20, s[24:27], s32 offen offset:2048  lds
    buffer_load_dwordx4 v21, s[24:27], s32 offen offset:3072  lds
    s_add_u32 m0, s33, 0x11000
    s_add_u32 s32, s32, 16384
    buffer_load_dwordx4 v18, s[24:27], s32 offen offset:0  lds
    buffer_load_dwordx4 v19, s[24:27], s32 offen offset:1024  lds
    buffer_load_dwordx4 v20, s[24:27], s32 offen offset:2048  lds
    buffer_load_dwordx4 v21, s[24:27], s32 offen offset:3072  lds
    s_waitcnt vmcnt(18)
    s_barrier
    s_add_u32 s32, s4, 1
    s_and_b32 s32, s32, 3
    s_lshl_b32 s32, s32, 8
    s_lshl_b32 s33, s37, 3
    s_add_u32 s32, s32, s33
    s_lshl_b32 s33, s37, 1
    s_add_u32 m0, s33, 0x0
    s_nop 0
    buffer_load_dwordx4 v18, s[24:27], s32 offen offset:0  lds
    buffer_load_dwordx4 v19, s[24:27], s32 offen offset:1024  lds
    buffer_load_dwordx4 v20, s[24:27], s32 offen offset:2048  lds
    buffer_load_dwordx4 v21, s[24:27], s32 offen offset:3072  lds
    s_add_u32 m0, s33, 0x1000
    s_add_u32 s32, s32, 16384
    buffer_load_dwordx4 v18, s[24:27], s32 offen offset:0  lds
    buffer_load_dwordx4 v19, s[24:27], s32 offen offset:1024  lds
    buffer_load_dwordx4 v20, s[24:27], s32 offen offset:2048  lds
    buffer_load_dwordx4 v21, s[24:27], s32 offen offset:3072  lds
    s_waitcnt vmcnt(24)
    s_barrier
    s_add_u32 s32, s4, 1
    s_and_b32 s32, s32, 3
    s_lshl_b32 s32, s32, 8
    s_lshl_b32 s33, s37, 3
    s_add_u32 s32, s32, s33
    s_add_u32 s32, s32, 0x20000
    s_lshl_b32 s33, s37, 1
    s_add_u32 m0, s33, 0x20000
    s_nop 0
    buffer_load_dwordx4 v18, s[24:27], s32 offen offset:0  lds
    buffer_load_dwordx4 v19, s[24:27], s32 offen offset:1024  lds
    buffer_load_dwordx4 v20, s[24:27], s32 offen offset:2048  lds
    buffer_load_dwordx4 v21, s[24:27], s32 offen offset:3072  lds
    s_add_u32 m0, s33, 0x21000
    s_add_u32 s32, s32, 16384
    buffer_load_dwordx4 v18, s[24:27], s32 offen offset:0  lds
    buffer_load_dwordx4 v19, s[24:27], s32 offen offset:1024  lds
    buffer_load_dwordx4 v20, s[24:27], s32 offen offset:2048  lds
    buffer_load_dwordx4 v21, s[24:27], s32 offen offset:3072  lds
    s_waitcnt vmcnt(24)
    s_barrier
    s_barrier
    s_waitcnt vmcnt(16)
    s_barrier
    s_add_u32 s32, s4, 2
    s_and_b32 s32, s32, 3
    s_lshl_b32 s32, s32, 8
    s_lshl_b32 s33, s37, 3
    s_add_u32 s32, s32, s33
    s_lshl_b32 s33, s37, 1
    s_add_u32 m0, s33, 0x8000
    s_nop 0
    buffer_load_dwordx4 v18, s[24:27], s32 offen offset:0  lds
    buffer_load_dwordx4 v19, s[24:27], s32 offen offset:1024  lds
    buffer_load_dwordx4 v20, s[24:27], s32 offen offset:2048  lds
    buffer_load_dwordx4 v21, s[24:27], s32 offen offset:3072  lds
    s_add_u32 m0, s33, 0x9000
    s_add_u32 s32, s32, 16384
    buffer_load_dwordx4 v18, s[24:27], s32 offen offset:0  lds
    buffer_load_dwordx4 v19, s[24:27], s32 offen offset:1024  lds
    buffer_load_dwordx4 v20, s[24:27], s32 offen offset:2048  lds
    buffer_load_dwordx4 v21, s[24:27], s32 offen offset:3072  lds
    s_waitcnt vmcnt(16)
    s_barrier
    s_add_u32 s32, s4, 2
    s_and_b32 s32, s32, 3
    s_lshl_b32 s32, s32, 8
    s_lshl_b32 s33, s37, 3
    s_add_u32 s32, s32, s33
    s_add_u32 s32, s32, 0x20000
    s_lshl_b32 s33, s37, 1
    s_add_u32 m0, s33, 0x10000
    s_nop 0
    buffer_load_dwordx4 v18, s[24:27], s32 offen offset:0  lds
    buffer_load_dwordx4 v19, s[24:27], s32 offen offset:1024  lds
    buffer_load_dwordx4 v20, s[24:27], s32 offen offset:2048  lds
    buffer_load_dwordx4 v21, s[24:27], s32 offen offset:3072  lds
    s_add_u32 m0, s33, 0x11000
    s_add_u32 s32, s32, 16384
    buffer_load_dwordx4 v18, s[24:27], s32 offen offset:0  lds
    buffer_load_dwordx4 v19, s[24:27], s32 offen offset:1024  lds
    buffer_load_dwordx4 v20, s[24:27], s32 offen offset:2048  lds
    buffer_load_dwordx4 v21, s[24:27], s32 offen offset:3072  lds
    s_waitcnt vmcnt(16)
    s_barrier
    s_add_u32 s32, s4, 3
    s_and_b32 s32, s32, 3
    s_lshl_b32 s32, s32, 8
    s_lshl_b32 s33, s37, 3
    s_add_u32 s32, s32, s33
    s_lshl_b32 s33, s37, 1
    s_add_u32 m0, s33, 0x0
    s_nop 0
    buffer_load_dwordx4 v18, s[24:27], s32 offen offset:0  lds
    buffer_load_dwordx4 v19, s[24:27], s32 offen offset:1024  lds
    buffer_load_dwordx4 v20, s[24:27], s32 offen offset:2048  lds
    buffer_load_dwordx4 v21, s[24:27], s32 offen offset:3072  lds
    s_add_u32 m0, s33, 0x1000
    s_add_u32 s32, s32, 16384
    buffer_load_dwordx4 v18, s[24:27], s32 offen offset:0  lds
    buffer_load_dwordx4 v19, s[24:27], s32 offen offset:1024  lds
    buffer_load_dwordx4 v20, s[24:27], s32 offen offset:2048  lds
    buffer_load_dwordx4 v21, s[24:27], s32 offen offset:3072  lds
    s_waitcnt vmcnt(16)
    s_barrier
    s_add_u32 s32, s4, 3
    s_and_b32 s32, s32, 3
    s_lshl_b32 s32, s32, 8
    s_lshl_b32 s33, s37, 3
    s_add_u32 s32, s32, s33
    s_add_u32 s32, s32, 0x20000
    s_lshl_b32 s33, s37, 1
    s_add_u32 m0, s33, 0x20000
    s_nop 0
    buffer_load_dwordx4 v18, s[24:27], s32 offen offset:0  lds
    buffer_load_dwordx4 v19, s[24:27], s32 offen offset:1024  lds
    buffer_load_dwordx4 v20, s[24:27], s32 offen offset:2048  lds
    buffer_load_dwordx4 v21, s[24:27], s32 offen offset:3072  lds
    s_add_u32 m0, s33, 0x21000
    s_add_u32 s32, s32, 16384
    buffer_load_dwordx4 v18, s[24:27], s32 offen offset:0  lds
    buffer_load_dwordx4 v19, s[24:27], s32 offen offset:1024  lds
    buffer_load_dwordx4 v20, s[24:27], s32 offen offset:2048  lds
    buffer_load_dwordx4 v21, s[24:27], s32 offen offset:3072  lds
    s_waitcnt vmcnt(16)
    s_barrier
    s_waitcnt vmcnt(8)
    s_barrier
    s_waitcnt vmcnt(0)
    s_barrier
    s_mov_b32 s48, s84
    s_mov_b32 s49, s85
    s_mov_b32 s50, 0xc0000
    s_mov_b32 s51, 0x20000
    s_lshl_b32 s42, s38, 4
    s_add_u32 s42, s42, s5
    s_mul_i32 s42, s42, 49152
    s_cmp_ge_u32 s3, 3
    s_cselect_b32 s67, 1, 0
    s_mul_i32 s68, s67, 3
    s_sub_u32 s68, s3, s68
    v_lshlrev_b32 v46, 4, v0
    s_lshl_b32 s64, s68, 10
    s_add_u32 s64, s64, s42
    s_mul_i32 s65, s67, 24576
    s_add_u32 s64, s64, s65
    s_lshl_b32 s66, s68, 11
    s_add_u32 s66, s66, 0
    v_lshlrev_b32 v47, 5, v0
    v_add_u32 v47, s66, v47
    s_and_b32 s65, s38, 7
    s_lshr_b32 s66, s38, 3
    s_mul_i32 s65, s65, 48
    s_lshl_b32 s68, s68, 4
    s_add_u32 s65, s65, s68
    s_lshl_b32 s65, s65, 11
    s_lshl_b32 s66, s66, 10
    s_add_u32 s65, s65, s66
    s_lshl_b32 s66, s5, 6
    s_add_u32 s65, s65, s66
    v_and_b32 v48, 15, v0
    v_lshrrev_b32 v49, 4, v0
    v_lshlrev_b32 v48, 11, v48
    v_lshl_add_u32 v48, v49, 3, v48
    s_mov_b32 s69, 0xffff0000
    v_mov_b32 v50, 0x2000
    s_lshl_b32 s32, s38, 8
    s_add_u32 s32, s32, 0xe00000
    v_mov_b32 v5, s32
    s_add_u32 s32, s32, 128
    v_mov_b32 v2, s32
    v_mov_b32 v3, 1
    v_mov_b32 v6, 1
    s_barrier
    s_cmp_lg_u32 s3, 4
    s_cbranch_scc1 L_NOSIG_A
    s_mov_b64 s[34:35], exec
    s_mov_b64 exec, 1
    buffer_atomic_add v6, v5, s[28:31], 0 offen sc1
    s_mov_b64 exec, s[34:35]
L_NOSIG_A:
    s_barrier
    s_cmp_lg_u32 s3, 4
    s_cbranch_scc1 L_REDUCE
    s_mov_b64 s[34:35], exec
    s_mov_b64 exec, 1
    buffer_atomic_add v3, v2, s[28:31], 0 offen sc0 sc1
    s_mov_b32 s36, 0
    s_lshr_b32 s32, s5, 2
    s_sub_u32 s32, s32, s4
    s_and_b32 s32, s32, 3
    s_cmp_ge_u32 s32, 2
    s_cbranch_scc1 L_LATE_SLICE
    v_mov_b32 v2, v5
    s_branch L_POLL_START
L_LATE_SLICE:
    s_waitcnt vmcnt(0)
    v_readfirstlane_b32 s33, v3
    s_cmp_ge_u32 s33, 15
    s_cbranch_scc1 L_POLL_DONE
L_POLL_START:
L_POLL:
    buffer_load_dword v52, v2, s[28:31], 0 offen sc1
    s_add_u32 s36, s36, 1
    s_waitcnt vmcnt(0)
    v_readfirstlane_b32 s33, v52
    s_cmp_ge_u32 s33, 16
    s_cbranch_scc1 L_POLL_DONE
    s_sleep 2
    s_cmp_lt_u32 s36, 0x100000
    s_cbranch_scc1 L_POLL
L_POLL_DONE:
    s_mov_b64 exec, s[34:35]
L_REDUCE:
    s_barrier
    s_cmp_ge_u32 s3, 6
    s_cbranch_scc1 L_RED_IDLE
    buffer_load_dwordx4 v[12:15], v46, s[28:31], s64 offen sc1
    s_add_u32 s64, s64, 3072
    buffer_load_dwordx4 v[16:19], v46, s[28:31], s64 offen sc1
    s_add_u32 s64, s64, 3072
    buffer_load_dwordx4 v[20:23], v46, s[28:31], s64 offen sc1
    s_add_u32 s64, s64, 3072
    buffer_load_dwordx4 v[24:27], v46, s[28:31], s64 offen sc1
    s_add_u32 s64, s64, 3072
    buffer_load_dwordx4 v[28:31], v46, s[28:31], s64 offen sc1
    s_add_u32 s64, s64, 3072
    buffer_load_dwordx4 v[32:35], v46, s[28:31], s64 offen sc1
    s_add_u32 s64, s64, 3072
    buffer_load_dwordx4 v[36:39], v46, s[28:31], s64 offen sc1
    s_add_u32 s64, s64, 3072
    buffer_load_dwordx4 v[40:43], v46, s[28:31], s64 offen sc1
    s_waitcnt vmcnt(7)
    v_lshlrev_b32 v4, 16, v12
    v_and_b32 v5, s69, v12
    v_lshlrev_b32 v6, 16, v13
    v_and_b32 v7, s69, v13
    v_lshlrev_b32 v8, 16, v14
    v_and_b32 v9, s69, v14
    v_lshlrev_b32 v10, 16, v15
    v_and_b32 v11, s69, v15
    s_waitcnt vmcnt(6)
    v_lshlrev_b32 v44, 16, v16
    v_and_b32 v45, s69, v16
    v_add_f32 v4, v4, v44
    v_add_f32 v5, v5, v45
    v_lshlrev_b32 v44, 16, v17
    v_and_b32 v45, s69, v17
    v_add_f32 v6, v6, v44
    v_add_f32 v7, v7, v45
    v_lshlrev_b32 v44, 16, v18
    v_and_b32 v45, s69, v18
    v_add_f32 v8, v8, v44
    v_add_f32 v9, v9, v45
    v_lshlrev_b32 v44, 16, v19
    v_and_b32 v45, s69, v19
    v_add_f32 v10, v10, v44
    v_add_f32 v11, v11, v45
    s_waitcnt vmcnt(5)
    v_lshlrev_b32 v44, 16, v20
    v_and_b32 v45, s69, v20
    v_add_f32 v4, v4, v44
    v_add_f32 v5, v5, v45
    v_lshlrev_b32 v44, 16, v21
    v_and_b32 v45, s69, v21
    v_add_f32 v6, v6, v44
    v_add_f32 v7, v7, v45
    v_lshlrev_b32 v44, 16, v22
    v_and_b32 v45, s69, v22
    v_add_f32 v8, v8, v44
    v_add_f32 v9, v9, v45
    v_lshlrev_b32 v44, 16, v23
    v_and_b32 v45, s69, v23
    v_add_f32 v10, v10, v44
    v_add_f32 v11, v11, v45
    s_waitcnt vmcnt(4)
    v_lshlrev_b32 v44, 16, v24
    v_and_b32 v45, s69, v24
    v_add_f32 v4, v4, v44
    v_add_f32 v5, v5, v45
    v_lshlrev_b32 v44, 16, v25
    v_and_b32 v45, s69, v25
    v_add_f32 v6, v6, v44
    v_add_f32 v7, v7, v45
    v_lshlrev_b32 v44, 16, v26
    v_and_b32 v45, s69, v26
    v_add_f32 v8, v8, v44
    v_add_f32 v9, v9, v45
    v_lshlrev_b32 v44, 16, v27
    v_and_b32 v45, s69, v27
    v_add_f32 v10, v10, v44
    v_add_f32 v11, v11, v45
    s_waitcnt vmcnt(3)
    v_lshlrev_b32 v44, 16, v28
    v_and_b32 v45, s69, v28
    v_add_f32 v4, v4, v44
    v_add_f32 v5, v5, v45
    v_lshlrev_b32 v44, 16, v29
    v_and_b32 v45, s69, v29
    v_add_f32 v6, v6, v44
    v_add_f32 v7, v7, v45
    v_lshlrev_b32 v44, 16, v30
    v_and_b32 v45, s69, v30
    v_add_f32 v8, v8, v44
    v_add_f32 v9, v9, v45
    v_lshlrev_b32 v44, 16, v31
    v_and_b32 v45, s69, v31
    v_add_f32 v10, v10, v44
    v_add_f32 v11, v11, v45
    s_waitcnt vmcnt(2)
    v_lshlrev_b32 v44, 16, v32
    v_and_b32 v45, s69, v32
    v_add_f32 v4, v4, v44
    v_add_f32 v5, v5, v45
    v_lshlrev_b32 v44, 16, v33
    v_and_b32 v45, s69, v33
    v_add_f32 v6, v6, v44
    v_add_f32 v7, v7, v45
    v_lshlrev_b32 v44, 16, v34
    v_and_b32 v45, s69, v34
    v_add_f32 v8, v8, v44
    v_add_f32 v9, v9, v45
    v_lshlrev_b32 v44, 16, v35
    v_and_b32 v45, s69, v35
    v_add_f32 v10, v10, v44
    v_add_f32 v11, v11, v45
    s_waitcnt vmcnt(1)
    v_lshlrev_b32 v44, 16, v36
    v_and_b32 v45, s69, v36
    v_add_f32 v4, v4, v44
    v_add_f32 v5, v5, v45
    v_lshlrev_b32 v44, 16, v37
    v_and_b32 v45, s69, v37
    v_add_f32 v6, v6, v44
    v_add_f32 v7, v7, v45
    v_lshlrev_b32 v44, 16, v38
    v_and_b32 v45, s69, v38
    v_add_f32 v8, v8, v44
    v_add_f32 v9, v9, v45
    v_lshlrev_b32 v44, 16, v39
    v_and_b32 v45, s69, v39
    v_add_f32 v10, v10, v44
    v_add_f32 v11, v11, v45
    s_waitcnt vmcnt(0)
    v_lshlrev_b32 v44, 16, v40
    v_and_b32 v45, s69, v40
    v_add_f32 v4, v4, v44
    v_add_f32 v5, v5, v45
    v_lshlrev_b32 v44, 16, v41
    v_and_b32 v45, s69, v41
    v_add_f32 v6, v6, v44
    v_add_f32 v7, v7, v45
    v_lshlrev_b32 v44, 16, v42
    v_and_b32 v45, s69, v42
    v_add_f32 v8, v8, v44
    v_add_f32 v9, v9, v45
    v_lshlrev_b32 v44, 16, v43
    v_and_b32 v45, s69, v43
    v_add_f32 v10, v10, v44
    v_add_f32_e64 v11, v11, v45
    s_cmp_eq_u32 s67, 0
    s_cbranch_scc1 L_RED_LOW
    ds_write_b128 v47, v[4:7]
    ds_write_b128 v47, v[8:11] offset:16
    s_waitcnt lgkmcnt(0)
    s_barrier
    s_branch L_RED_DONE
L_RED_LOW:
    s_barrier
    ds_read_b128 v[12:15], v47
    ds_read_b128 v[16:19], v47 offset:16
    s_waitcnt lgkmcnt(0)
    v_add_f32 v4, v4, v12
    v_add_f32 v5, v5, v13
    v_add_f32 v6, v6, v14
    v_add_f32 v7, v7, v15
    v_add_f32 v8, v8, v16
    v_add_f32 v9, v9, v17
    v_add_f32 v10, v10, v18
    v_add_f32_e64 v11, v11, v19
    v_cvt_pk_bf16_f32 v4, v4, v5
    v_cvt_pk_bf16_f32 v5, v6, v7
    v_cvt_pk_bf16_f32 v6, v8, v9
    v_cvt_pk_bf16_f32 v7, v10, v11
    buffer_store_dwordx2 v[4:5], v48, s[48:51], s65 offen
    buffer_store_dwordx2 v[6:7], v48, s[48:51], s65 offen offset:32
L_RED_DONE:
    s_branch L_END
L_RED_IDLE:
    s_barrier
L_END:
    s_endpgm
L_RARE_0:
    s_nop 15
    v_max3_f32 v228, v128, v129, v130
    v_max3_f32 v228, v228, v131, v132
    v_max3_f32 v228, v228, v133, v134
    v_max3_f32 v228, v228, v135, v136
    v_max3_f32 v228, v228, v137, v138
    v_max3_f32 v228, v228, v139, v140
    v_max3_f32 v228, v228, v141, v142
    v_max_f32 v228, v228, v143
    v_mov_b32 v31, v228
    s_nop 1
    v_permlane32_swap_b32 v228, v31
    s_nop 1
    v_max_f32 v228, v228, v31
    v_max_f32_e64 v228, 0, v228
    v_exp_f32 v229, -v228
    v_sub_f32 v160, v160, v228
    v_sub_f32 v161, v161, v228
    v_sub_f32 v162, v162, v228
    v_sub_f32 v163, v163, v228
    v_sub_f32 v164, v164, v228
    v_sub_f32 v165, v165, v228
    v_sub_f32 v166, v166, v228
    v_sub_f32 v167, v167, v228
    v_sub_f32 v168, v168, v228
    v_sub_f32 v169, v169, v228
    v_sub_f32 v170, v170, v228
    v_sub_f32 v171, v171, v228
    v_sub_f32 v172, v172, v228
    v_sub_f32 v173, v173, v228
    v_sub_f32 v174, v174, v228
    v_sub_f32 v175, v175, v228
    v_sub_f32 v128, v128, v228
    v_sub_f32 v129, v129, v228
    v_sub_f32 v130, v130, v228
    v_sub_f32 v131, v131, v228
    v_sub_f32 v132, v132, v228
    v_sub_f32 v133, v133, v228
    v_sub_f32 v134, v134, v228
    v_sub_f32 v135, v135, v228
    v_sub_f32 v136, v136, v228
    v_sub_f32 v137, v137, v228
    v_sub_f32 v138, v138, v228
    v_sub_f32 v139, v139, v228
    v_sub_f32 v140, v140, v228
    v_sub_f32 v141, v141, v228
    v_sub_f32 v142, v142, v228
    v_sub_f32 v143, v143, v228
    v_sub_f32 v144, v144, v228
    v_sub_f32 v145, v145, v228
    v_sub_f32 v146, v146, v228
    v_sub_f32 v147, v147, v228
    v_sub_f32 v148, v148, v228
    v_sub_f32 v149, v149, v228
    v_sub_f32 v150, v150, v228
    v_sub_f32 v151, v151, v228
    v_sub_f32 v152, v152, v228
    v_sub_f32 v153, v153, v228
    v_sub_f32 v154, v154, v228
    v_sub_f32 v155, v155, v228
    v_sub_f32 v156, v156, v228
    v_sub_f32 v157, v157, v228
    v_sub_f32 v158, v158, v228
    v_sub_f32 v159, v159, v228
    v_mul_f32 v64, v64, v229
    v_mul_f32 v65, v65, v229
    v_mul_f32 v66, v66, v229
    v_mul_f32 v67, v67, v229
    v_mul_f32 v68, v68, v229
    v_mul_f32 v69, v69, v229
    v_mul_f32 v70, v70, v229
    v_mul_f32 v71, v71, v229
    v_mul_f32 v72, v72, v229
    v_mul_f32 v73, v73, v229
    v_mul_f32 v74, v74, v229
    v_mul_f32 v75, v75, v229
    v_mul_f32 v76, v76, v229
    v_mul_f32 v77, v77, v229
    v_mul_f32 v78, v78, v229
    v_mul_f32 v79, v79, v229
    v_mul_f32 v80, v80, v229
    v_mul_f32 v81, v81, v229
    v_mul_f32 v82, v82, v229
    v_mul_f32 v83, v83, v229
    v_mul_f32 v84, v84, v229
    v_mul_f32 v85, v85, v229
    v_mul_f32 v86, v86, v229
    v_mul_f32 v87, v87, v229
    v_mul_f32 v88, v88, v229
    v_mul_f32 v89, v89, v229
    v_mul_f32 v90, v90, v229
    v_mul_f32 v91, v91, v229
    v_mul_f32 v92, v92, v229
    v_mul_f32 v93, v93, v229
    v_mul_f32 v94, v94, v229
    v_mul_f32 v95, v95, v229
    v_mul_f32 v96, v96, v229
    v_mul_f32 v97, v97, v229
    v_mul_f32 v98, v98, v229
    v_mul_f32 v99, v99, v229
    v_mul_f32 v100, v100, v229
    v_mul_f32 v101, v101, v229
    v_mul_f32 v102, v102, v229
    v_mul_f32 v103, v103, v229
    v_mul_f32 v104, v104, v229
    v_mul_f32 v105, v105, v229
    v_mul_f32 v106, v106, v229
    v_mul_f32 v107, v107, v229
    v_mul_f32 v108, v108, v229
    v_mul_f32 v109, v109, v229
    v_mul_f32 v110, v110, v229
    v_mul_f32 v111, v111, v229
    v_mul_f32 v112, v112, v229
    v_mul_f32 v113, v113, v229
    v_mul_f32 v114, v114, v229
    v_mul_f32 v115, v115, v229
    v_mul_f32 v116, v116, v229
    v_mul_f32 v117, v117, v229
    v_mul_f32 v118, v118, v229
    v_mul_f32 v119, v119, v229
    v_mul_f32 v120, v120, v229
    v_mul_f32 v121, v121, v229
    v_mul_f32 v122, v122, v229
    v_mul_f32 v123, v123, v229
    v_mul_f32 v124, v124, v229
    v_mul_f32 v125, v125, v229
    v_mul_f32 v126, v126, v229
    v_mul_f32 v127, v127, v229
    v_mul_f32 v30, v30, v229
    v_mov_b32 v28, 0
    v_exp_f32 v224, v128
    v_exp_f32 v225, v129
    v_add_f32 v28, v28, v224
    v_add_f32 v28, v28, v225
    v_cvt_pk_bf16_f32 v176, v224, v225
    v_exp_f32 v224, v130
    v_exp_f32 v225, v131
    v_add_f32 v28, v28, v224
    v_add_f32 v28, v28, v225
    v_cvt_pk_bf16_f32 v177, v224, v225
    v_exp_f32 v224, v132
    v_exp_f32 v225, v133
    v_add_f32 v28, v28, v224
    v_add_f32 v28, v28, v225
    v_cvt_pk_bf16_f32 v178, v224, v225
    v_exp_f32 v224, v134
    v_exp_f32 v225, v135
    v_add_f32 v28, v28, v224
    v_add_f32 v28, v28, v225
    v_cvt_pk_bf16_f32 v179, v224, v225
    v_exp_f32 v224, v136
    v_exp_f32 v225, v137
    v_add_f32 v28, v28, v224
    v_add_f32 v28, v28, v225
    v_cvt_pk_bf16_f32 v180, v224, v225
    v_exp_f32 v224, v138
    v_exp_f32 v225, v139
    v_add_f32 v28, v28, v224
    v_add_f32 v28, v28, v225
    v_cvt_pk_bf16_f32 v181, v224, v225
    v_exp_f32 v224, v140
    v_exp_f32 v225, v141
    v_add_f32 v28, v28, v224
    v_add_f32 v28, v28, v225
    v_cvt_pk_bf16_f32 v182, v224, v225
    v_exp_f32 v224, v142
    v_exp_f32 v225, v143
    v_add_f32 v28, v28, v224
    v_add_f32 v28, v28, v225
    v_cvt_pk_bf16_f32 v183, v224, v225
    s_nop 1
    s_branch L_RARE_0_BACK
L_RARE_L1:
    s_nop 15
    v_max3_f32 v228, v144, v145, v146
    v_max3_f32 v228, v228, v147, v148
    v_max3_f32 v228, v228, v149, v150
    v_max3_f32 v228, v228, v151, v152
    v_max3_f32 v228, v228, v153, v154
    v_max3_f32 v228, v228, v155, v156
    v_max3_f32 v228, v228, v157, v158
    v_max_f32 v228, v228, v159
    v_mov_b32 v31, v228
    s_nop 1
    v_permlane32_swap_b32 v228, v31
    s_nop 1
    v_max_f32 v228, v228, v31
    v_max_f32 v228, 0, v228
    v_exp_f32 v229, -v228
    v_sub_f32 v160, v160, v228
    v_sub_f32 v161, v161, v228
    v_sub_f32 v162, v162, v228
    v_sub_f32 v163, v163, v228
    v_sub_f32 v164, v164, v228
    v_sub_f32 v165, v165, v228
    v_sub_f32 v166, v166, v228
    v_sub_f32 v167, v167, v228
    v_sub_f32 v168, v168, v228
    v_sub_f32 v169, v169, v228
    v_sub_f32 v170, v170, v228
    v_sub_f32 v171, v171, v228
    v_sub_f32 v172, v172, v228
    v_sub_f32 v173, v173, v228
    v_sub_f32 v174, v174, v228
    v_sub_f32 v175, v175, v228
    v_sub_f32 v144, v144, v228
    v_sub_f32 v145, v145, v228
    v_sub_f32 v146, v146, v228
    v_sub_f32 v147, v147, v228
    v_sub_f32 v148, v148, v228
    v_sub_f32 v149, v149, v228
    v_sub_f32 v150, v150, v228
    v_sub_f32 v151, v151, v228
    v_sub_f32 v152, v152, v228
    v_sub_f32 v153, v153, v228
    v_sub_f32 v154, v154, v228
    v_sub_f32 v155, v155, v228
    v_sub_f32 v156, v156, v228
    v_sub_f32 v157, v157, v228
    v_sub_f32 v158, v158, v228
    v_sub_f32 v159, v159, v228
    v_sub_f32 v128, v128, v228
    v_sub_f32 v129, v129, v228
    v_sub_f32 v130, v130, v228
    v_sub_f32 v131, v131, v228
    v_sub_f32 v132, v132, v228
    v_sub_f32 v133, v133, v228
    v_sub_f32 v134, v134, v228
    v_sub_f32 v135, v135, v228
    v_sub_f32 v136, v136, v228
    v_sub_f32 v137, v137, v228
    v_sub_f32 v138, v138, v228
    v_sub_f32 v139, v139, v228
    v_sub_f32 v140, v140, v228
    v_sub_f32 v141, v141, v228
    v_sub_f32 v142, v142, v228
    v_sub_f32 v143, v143, v228
    v_mul_f32 v64, v64, v229
    v_mul_f32 v65, v65, v229
    v_mul_f32 v66, v66, v229
    v_mul_f32 v67, v67, v229
    v_mul_f32 v68, v68, v229
    v_mul_f32 v69, v69, v229
    v_mul_f32 v70, v70, v229
    v_mul_f32 v71, v71, v229
    v_mul_f32 v72, v72, v229
    v_mul_f32 v73, v73, v229
    v_mul_f32 v74, v74, v229
    v_mul_f32 v75, v75, v229
    v_mul_f32 v76, v76, v229
    v_mul_f32 v77, v77, v229
    v_mul_f32 v78, v78, v229
    v_mul_f32 v79, v79, v229
    v_mul_f32 v80, v80, v229
    v_mul_f32 v81, v81, v229
    v_mul_f32 v82, v82, v229
    v_mul_f32 v83, v83, v229
    v_mul_f32 v84, v84, v229
    v_mul_f32 v85, v85, v229
    v_mul_f32 v86, v86, v229
    v_mul_f32 v87, v87, v229
    v_mul_f32 v88, v88, v229
    v_mul_f32 v89, v89, v229
    v_mul_f32 v90, v90, v229
    v_mul_f32 v91, v91, v229
    v_mul_f32 v92, v92, v229
    v_mul_f32 v93, v93, v229
    v_mul_f32 v94, v94, v229
    v_mul_f32 v95, v95, v229
    v_mul_f32 v96, v96, v229
    v_mul_f32 v97, v97, v229
    v_mul_f32 v98, v98, v229
    v_mul_f32 v99, v99, v229
    v_mul_f32 v100, v100, v229
    v_mul_f32 v101, v101, v229
    v_mul_f32 v102, v102, v229
    v_mul_f32 v103, v103, v229
    v_mul_f32 v104, v104, v229
    v_mul_f32 v105, v105, v229
    v_mul_f32 v106, v106, v229
    v_mul_f32 v107, v107, v229
    v_mul_f32 v108, v108, v229
    v_mul_f32 v109, v109, v229
    v_mul_f32 v110, v110, v229
    v_mul_f32 v111, v111, v229
    v_mul_f32 v112, v112, v229
    v_mul_f32 v113, v113, v229
    v_mul_f32 v114, v114, v229
    v_mul_f32 v115, v115, v229
    v_mul_f32 v116, v116, v229
    v_mul_f32 v117, v117, v229
    v_mul_f32 v118, v118, v229
    v_mul_f32 v119, v119, v229
    v_mul_f32 v120, v120, v229
    v_mul_f32 v121, v121, v229
    v_mul_f32 v122, v122, v229
    v_mul_f32 v123, v123, v229
    v_mul_f32 v124, v124, v229
    v_mul_f32 v125, v125, v229
    v_mul_f32 v126, v126, v229
    v_mul_f32 v127, v127, v229
    v_mul_f32 v30, v30, v229
    v_mov_b32 v28, 0
    v_exp_f32 v224, v144
    v_exp_f32 v225, v145
    v_add_f32 v28, v28, v224
    v_add_f32 v28, v28, v225
    v_cvt_pk_bf16_f32 v184, v224, v225
    v_exp_f32 v224, v146
    v_exp_f32 v225, v147
    v_add_f32 v28, v28, v224
    v_add_f32 v28, v28, v225
    v_cvt_pk_bf16_f32 v185, v224, v225
    v_exp_f32 v224, v148
    v_exp_f32 v225, v149
    v_add_f32 v28, v28, v224
    v_add_f32 v28, v28, v225
    v_cvt_pk_bf16_f32 v186, v224, v225
    v_exp_f32 v224, v150
    v_exp_f32 v225, v151
    v_add_f32 v28, v28, v224
    v_add_f32 v28, v28, v225
    v_cvt_pk_bf16_f32 v187, v224, v225
    v_exp_f32 v224, v152
    v_exp_f32 v225, v153
    v_add_f32 v28, v28, v224
    v_add_f32 v28, v28, v225
    v_cvt_pk_bf16_f32 v188, v224, v225
    v_exp_f32 v224, v154
    v_exp_f32 v225, v155
    v_add_f32 v28, v28, v224
    v_add_f32 v28, v28, v225
    v_cvt_pk_bf16_f32 v189, v224, v225
    v_exp_f32 v224, v156
    v_exp_f32 v225, v157
    v_add_f32 v28, v28, v224
    v_add_f32 v28, v28, v225
    v_cvt_pk_bf16_f32 v190, v224, v225
    v_exp_f32 v224, v158
    v_exp_f32 v225, v159
    v_add_f32 v28, v28, v224
    v_add_f32 v28, v28, v225
    v_cvt_pk_bf16_f32 v191, v224, v225
    s_nop 1
    s_branch L_RARE_L1_BACK
L_RARE_L2:
    s_nop 15
    v_max3_f32 v228, v128, v129, v130
    v_max3_f32 v228, v228, v131, v132
    v_max3_f32 v228, v228, v133, v134
    v_max3_f32 v228, v228, v135, v136
    v_max3_f32 v228, v228, v137, v138
    v_max3_f32 v228, v228, v139, v140
    v_max3_f32 v228, v228, v141, v142
    v_max_f32 v228, v228, v143
    v_mov_b32 v31, v228
    s_nop 1
    v_permlane32_swap_b32 v228, v31
    s_nop 1
    v_max_f32 v228, v228, v31
    v_max_f32 v228, 0, v228
    v_exp_f32 v229, -v228
    v_sub_f32 v160, v160, v228
    v_sub_f32 v161, v161, v228
    v_sub_f32 v162, v162, v228
    v_sub_f32 v163, v163, v228
    v_sub_f32 v164, v164, v228
    v_sub_f32 v165, v165, v228
    v_sub_f32 v166, v166, v228
    v_sub_f32 v167, v167, v228
    v_sub_f32 v168, v168, v228
    v_sub_f32 v169, v169, v228
    v_sub_f32 v170, v170, v228
    v_sub_f32 v171, v171, v228
    v_sub_f32 v172, v172, v228
    v_sub_f32 v173, v173, v228
    v_sub_f32 v174, v174, v228
    v_sub_f32 v175, v175, v228
    v_sub_f32 v128, v128, v228
    v_sub_f32 v129, v129, v228
    v_sub_f32 v130, v130, v228
    v_sub_f32 v131, v131, v228
    v_sub_f32 v132, v132, v228
    v_sub_f32 v133, v133, v228
    v_sub_f32 v134, v134, v228
    v_sub_f32 v135, v135, v228
    v_sub_f32 v136, v136, v228
    v_sub_f32 v137, v137, v228
    v_sub_f32 v138, v138, v228
    v_sub_f32 v139, v139, v228
    v_sub_f32 v140, v140, v228
    v_sub_f32 v141, v141, v228
    v_sub_f32 v142, v142, v228
    v_sub_f32 v143, v143, v228
    v_sub_f32 v144, v144, v228
    v_sub_f32 v145, v145, v228
    v_sub_f32 v146, v146, v228
    v_sub_f32 v147, v147, v228
    v_sub_f32 v148, v148, v228
    v_sub_f32 v149, v149, v228
    v_sub_f32 v150, v150, v228
    v_sub_f32 v151, v151, v228
    v_sub_f32 v152, v152, v228
    v_sub_f32 v153, v153, v228
    v_sub_f32 v154, v154, v228
    v_sub_f32 v155, v155, v228
    v_sub_f32 v156, v156, v228
    v_sub_f32 v157, v157, v228
    v_sub_f32 v158, v158, v228
    v_sub_f32 v159, v159, v228
    v_mul_f32 v64, v64, v229
    v_mul_f32 v65, v65, v229
    v_mul_f32 v66, v66, v229
    v_mul_f32 v67, v67, v229
    v_mul_f32 v68, v68, v229
    v_mul_f32 v69, v69, v229
    v_mul_f32 v70, v70, v229
    v_mul_f32 v71, v71, v229
    v_mul_f32 v72, v72, v229
    v_mul_f32 v73, v73, v229
    v_mul_f32 v74, v74, v229
    v_mul_f32 v75, v75, v229
    v_mul_f32 v76, v76, v229
    v_mul_f32 v77, v77, v229
    v_mul_f32 v78, v78, v229
    v_mul_f32 v79, v79, v229
    v_mul_f32 v80, v80, v229
    v_mul_f32 v81, v81, v229
    v_mul_f32 v82, v82, v229
    v_mul_f32 v83, v83, v229
    v_mul_f32 v84, v84, v229
    v_mul_f32 v85, v85, v229
    v_mul_f32 v86, v86, v229
    v_mul_f32 v87, v87, v229
    v_mul_f32 v88, v88, v229
    v_mul_f32 v89, v89, v229
    v_mul_f32 v90, v90, v229
    v_mul_f32 v91, v91, v229
    v_mul_f32 v92, v92, v229
    v_mul_f32 v93, v93, v229
    v_mul_f32 v94, v94, v229
    v_mul_f32 v95, v95, v229
    v_mul_f32 v96, v96, v229
    v_mul_f32 v97, v97, v229
    v_mul_f32 v98, v98, v229
    v_mul_f32 v99, v99, v229
    v_mul_f32 v100, v100, v229
    v_mul_f32 v101, v101, v229
    v_mul_f32 v102, v102, v229
    v_mul_f32 v103, v103, v229
    v_mul_f32 v104, v104, v229
    v_mul_f32 v105, v105, v229
    v_mul_f32 v106, v106, v229
    v_mul_f32 v107, v107, v229
    v_mul_f32 v108, v108, v229
    v_mul_f32 v109, v109, v229
    v_mul_f32 v110, v110, v229
    v_mul_f32 v111, v111, v229
    v_mul_f32 v112, v112, v229
    v_mul_f32 v113, v113, v229
    v_mul_f32 v114, v114, v229
    v_mul_f32 v115, v115, v229
    v_mul_f32 v116, v116, v229
    v_mul_f32 v117, v117, v229
    v_mul_f32 v118, v118, v229
    v_mul_f32 v119, v119, v229
    v_mul_f32 v120, v120, v229
    v_mul_f32 v121, v121, v229
    v_mul_f32 v122, v122, v229
    v_mul_f32 v123, v123, v229
    v_mul_f32 v124, v124, v229
    v_mul_f32 v125, v125, v229
    v_mul_f32 v126, v126, v229
    v_mul_f32 v127, v127, v229
    v_mul_f32 v30, v30, v229
    v_mov_b32 v28, 0
    v_exp_f32 v224, v128
    v_exp_f32 v225, v129
    v_add_f32 v28, v28, v224
    v_add_f32 v28, v28, v225
    v_cvt_pk_bf16_f32 v176, v224, v225
    v_exp_f32 v224, v130
    v_exp_f32 v225, v131
    v_add_f32 v28, v28, v224
    v_add_f32 v28, v28, v225
    v_cvt_pk_bf16_f32 v177, v224, v225
    v_exp_f32 v224, v132
    v_exp_f32 v225, v133
    v_add_f32 v28, v28, v224
    v_add_f32 v28, v28, v225
    v_cvt_pk_bf16_f32 v178, v224, v225
    v_exp_f32 v224, v134
    v_exp_f32 v225, v135
    v_add_f32 v28, v28, v224
    v_add_f32 v28, v28, v225
    v_cvt_pk_bf16_f32 v179, v224, v225
    v_exp_f32 v224, v136
    v_exp_f32 v225, v137
    v_add_f32 v28, v28, v224
    v_add_f32 v28, v28, v225
    v_cvt_pk_bf16_f32 v180, v224, v225
    v_exp_f32 v224, v138
    v_exp_f32 v225, v139
    v_add_f32 v28, v28, v224
    v_add_f32 v28, v28, v225
    v_cvt_pk_bf16_f32 v181, v224, v225
    v_exp_f32 v224, v140
    v_exp_f32 v225, v141
    v_add_f32 v28, v28, v224
    v_add_f32 v28, v28, v225
    v_cvt_pk_bf16_f32 v182, v224, v225
    v_exp_f32 v224, v142
    v_exp_f32 v225, v143
    v_add_f32 v28, v28, v224
    v_add_f32 v28, v28, v225
    v_cvt_pk_bf16_f32 v183, v224, v225
    s_nop 1
    s_branch L_RARE_L2_BACK
L_RARE_L3:
    s_nop 15
    v_max3_f32 v228, v144, v145, v146
    v_max3_f32 v228, v228, v147, v148
    v_max3_f32 v228, v228, v149, v150
    v_max3_f32 v228, v228, v151, v152
    v_max3_f32 v228, v228, v153, v154
    v_max3_f32 v228, v228, v155, v156
    v_max3_f32 v228, v228, v157, v158
    v_max_f32 v228, v228, v159
    v_mov_b32 v31, v228
    s_nop 1
    v_permlane32_swap_b32 v228, v31
    s_nop 1
    v_max_f32 v228, v228, v31
    v_max_f32 v228, 0, v228
    v_exp_f32 v229, -v228
    v_sub_f32 v160, v160, v228
    v_sub_f32 v161, v161, v228
    v_sub_f32 v162, v162, v228
    v_sub_f32 v163, v163, v228
    v_sub_f32 v164, v164, v228
    v_sub_f32 v165, v165, v228
    v_sub_f32 v166, v166, v228
    v_sub_f32 v167, v167, v228
    v_sub_f32 v168, v168, v228
    v_sub_f32 v169, v169, v228
    v_sub_f32 v170, v170, v228
    v_sub_f32 v171, v171, v228
    v_sub_f32 v172, v172, v228
    v_sub_f32 v173, v173, v228
    v_sub_f32 v174, v174, v228
    v_sub_f32 v175, v175, v228
    v_sub_f32 v144, v144, v228
    v_sub_f32 v145, v145, v228
    v_sub_f32 v146, v146, v228
    v_sub_f32 v147, v147, v228
    v_sub_f32 v148, v148, v228
    v_sub_f32 v149, v149, v228
    v_sub_f32 v150, v150, v228
    v_sub_f32 v151, v151, v228
    v_sub_f32 v152, v152, v228
    v_sub_f32 v153, v153, v228
    v_sub_f32 v154, v154, v228
    v_sub_f32 v155, v155, v228
    v_sub_f32 v156, v156, v228
    v_sub_f32 v157, v157, v228
    v_sub_f32 v158, v158, v228
    v_sub_f32 v159, v159, v228
    v_sub_f32 v128, v128, v228
    v_sub_f32 v129, v129, v228
    v_sub_f32 v130, v130, v228
    v_sub_f32 v131, v131, v228
    v_sub_f32 v132, v132, v228
    v_sub_f32 v133, v133, v228
    v_sub_f32 v134, v134, v228
    v_sub_f32 v135, v135, v228
    v_sub_f32 v136, v136, v228
    v_sub_f32 v137, v137, v228
    v_sub_f32 v138, v138, v228
    v_sub_f32 v139, v139, v228
    v_sub_f32 v140, v140, v228
    v_sub_f32 v141, v141, v228
    v_sub_f32 v142, v142, v228
    v_sub_f32 v143, v143, v228
    v_mul_f32 v64, v64, v229
    v_mul_f32 v65, v65, v229
    v_mul_f32 v66, v66, v229
    v_mul_f32 v67, v67, v229
    v_mul_f32 v68, v68, v229
    v_mul_f32 v69, v69, v229
    v_mul_f32 v70, v70, v229
    v_mul_f32 v71, v71, v229
    v_mul_f32 v72, v72, v229
    v_mul_f32 v73, v73, v229
    v_mul_f32 v74, v74, v229
    v_mul_f32 v75, v75, v229
    v_mul_f32 v76, v76, v229
    v_mul_f32 v77, v77, v229
    v_mul_f32 v78, v78, v229
    v_mul_f32 v79, v79, v229
    v_mul_f32 v80, v80, v229
    v_mul_f32 v81, v81, v229
    v_mul_f32 v82, v82, v229
    v_mul_f32 v83, v83, v229
    v_mul_f32 v84, v84, v229
    v_mul_f32 v85, v85, v229
    v_mul_f32 v86, v86, v229
    v_mul_f32 v87, v87, v229
    v_mul_f32 v88, v88, v229
    v_mul_f32 v89, v89, v229
    v_mul_f32 v90, v90, v229
    v_mul_f32 v91, v91, v229
    v_mul_f32 v92, v92, v229
    v_mul_f32 v93, v93, v229
    v_mul_f32 v94, v94, v229
    v_mul_f32 v95, v95, v229
    v_mul_f32 v96, v96, v229
    v_mul_f32 v97, v97, v229
    v_mul_f32 v98, v98, v229
    v_mul_f32 v99, v99, v229
    v_mul_f32 v100, v100, v229
    v_mul_f32 v101, v101, v229
    v_mul_f32 v102, v102, v229
    v_mul_f32 v103, v103, v229
    v_mul_f32 v104, v104, v229
    v_mul_f32 v105, v105, v229
    v_mul_f32 v106, v106, v229
    v_mul_f32 v107, v107, v229
    v_mul_f32 v108, v108, v229
    v_mul_f32 v109, v109, v229
    v_mul_f32 v110, v110, v229
    v_mul_f32 v111, v111, v229
    v_mul_f32 v112, v112, v229
    v_mul_f32 v113, v113, v229
    v_mul_f32 v114, v114, v229
    v_mul_f32 v115, v115, v229
    v_mul_f32 v116, v116, v229
    v_mul_f32 v117, v117, v229
    v_mul_f32 v118, v118, v229
    v_mul_f32 v119, v119, v229
    v_mul_f32 v120, v120, v229
    v_mul_f32 v121, v121, v229
    v_mul_f32 v122, v122, v229
    v_mul_f32 v123, v123, v229
    v_mul_f32 v124, v124, v229
    v_mul_f32 v125, v125, v229
    v_mul_f32 v126, v126, v229
    v_mul_f32 v127, v127, v229
    v_mul_f32 v30, v30, v229
    v_mov_b32 v28, 0
    v_exp_f32 v224, v144
    v_exp_f32 v225, v145
    v_add_f32 v28, v28, v224
    v_add_f32 v28, v28, v225
    v_cvt_pk_bf16_f32 v184, v224, v225
    v_exp_f32 v224, v146
    v_exp_f32 v225, v147
    v_add_f32 v28, v28, v224
    v_add_f32 v28, v28, v225
    v_cvt_pk_bf16_f32 v185, v224, v225
    v_exp_f32 v224, v148
    v_exp_f32 v225, v149
    v_add_f32 v28, v28, v224
    v_add_f32 v28, v28, v225
    v_cvt_pk_bf16_f32 v186, v224, v225
    v_exp_f32 v224, v150
    v_exp_f32 v225, v151
    v_add_f32 v28, v28, v224
    v_add_f32 v28, v28, v225
    v_cvt_pk_bf16_f32 v187, v224, v225
    v_exp_f32 v224, v152
    v_exp_f32 v225, v153
    v_add_f32 v28, v28, v224
    v_add_f32 v28, v28, v225
    v_cvt_pk_bf16_f32 v188, v224, v225
    v_exp_f32 v224, v154
    v_exp_f32 v225, v155
    v_add_f32 v28, v28, v224
    v_add_f32 v28, v28, v225
    v_cvt_pk_bf16_f32 v189, v224, v225
    v_exp_f32 v224, v156
    v_exp_f32 v225, v157
    v_add_f32 v28, v28, v224
    v_add_f32 v28, v28, v225
    v_cvt_pk_bf16_f32 v190, v224, v225
    v_exp_f32 v224, v158
    v_exp_f32 v225, v159
    v_add_f32 v28, v28, v224
    v_add_f32 v28, v28, v225
    v_cvt_pk_bf16_f32 v191, v224, v225
    s_nop 1
    s_branch L_RARE_L3_BACK
L_RARE_L4:
    s_nop 15
    v_max3_f32 v228, v128, v129, v130
    v_max3_f32 v228, v228, v131, v132
    v_max3_f32 v228, v228, v133, v134
    v_max3_f32 v228, v228, v135, v136
    v_max3_f32 v228, v228, v137, v138
    v_max3_f32 v228, v228, v139, v140
    v_max3_f32 v228, v228, v141, v142
    v_max_f32 v228, v228, v143
    v_mov_b32 v31, v228
    s_nop 1
    v_permlane32_swap_b32 v228, v31
    s_nop 1
    v_max_f32 v228, v228, v31
    v_max_f32 v228, 0, v228
    v_exp_f32 v229, -v228
    v_sub_f32 v160, v160, v228
    v_sub_f32 v161, v161, v228
    v_sub_f32 v162, v162, v228
    v_sub_f32 v163, v163, v228
    v_sub_f32 v164, v164, v228
    v_sub_f32 v165, v165, v228
    v_sub_f32 v166, v166, v228
    v_sub_f32 v167, v167, v228
    v_sub_f32 v168, v168, v228
    v_sub_f32 v169, v169, v228
    v_sub_f32 v170, v170, v228
    v_sub_f32 v171, v171, v228
    v_sub_f32 v172, v172, v228
    v_sub_f32 v173, v173, v228
    v_sub_f32 v174, v174, v228
    v_sub_f32 v175, v175, v228
    v_sub_f32 v128, v128, v228
    v_sub_f32 v129, v129, v228
    v_sub_f32 v130, v130, v228
    v_sub_f32 v131, v131, v228
    v_sub_f32 v132, v132, v228
    v_sub_f32 v133, v133, v228
    v_sub_f32 v134, v134, v228
    v_sub_f32 v135, v135, v228
    v_sub_f32 v136, v136, v228
    v_sub_f32 v137, v137, v228
    v_sub_f32 v138, v138, v228
    v_sub_f32 v139, v139, v228
    v_sub_f32 v140, v140, v228
    v_sub_f32 v141, v141, v228
    v_sub_f32 v142, v142, v228
    v_sub_f32 v143, v143, v228
    v_sub_f32 v144, v144, v228
    v_sub_f32 v145, v145, v228
    v_sub_f32 v146, v146, v228
    v_sub_f32 v147, v147, v228
    v_sub_f32 v148, v148, v228
    v_sub_f32 v149, v149, v228
    v_sub_f32 v150, v150, v228
    v_sub_f32 v151, v151, v228
    v_sub_f32 v152, v152, v228
    v_sub_f32 v153, v153, v228
    v_sub_f32 v154, v154, v228
    v_sub_f32 v155, v155, v228
    v_sub_f32 v156, v156, v228
    v_sub_f32 v157, v157, v228
    v_sub_f32 v158, v158, v228
    v_sub_f32 v159, v159, v228
    v_mul_f32 v64, v64, v229
    v_mul_f32 v65, v65, v229
    v_mul_f32 v66, v66, v229
    v_mul_f32 v67, v67, v229
    v_mul_f32 v68, v68, v229
    v_mul_f32 v69, v69, v229
    v_mul_f32 v70, v70, v229
    v_mul_f32 v71, v71, v229
    v_mul_f32 v72, v72, v229
    v_mul_f32 v73, v73, v229
    v_mul_f32 v74, v74, v229
    v_mul_f32 v75, v75, v229
    v_mul_f32 v76, v76, v229
    v_mul_f32 v77, v77, v229
    v_mul_f32 v78, v78, v229
    v_mul_f32 v79, v79, v229
    v_mul_f32 v80, v80, v229
    v_mul_f32 v81, v81, v229
    v_mul_f32 v82, v82, v229
    v_mul_f32 v83, v83, v229
    v_mul_f32 v84, v84, v229
    v_mul_f32 v85, v85, v229
    v_mul_f32 v86, v86, v229
    v_mul_f32 v87, v87, v229
    v_mul_f32 v88, v88, v229
    v_mul_f32 v89, v89, v229
    v_mul_f32 v90, v90, v229
    v_mul_f32 v91, v91, v229
    v_mul_f32 v92, v92, v229
    v_mul_f32 v93, v93, v229
    v_mul_f32 v94, v94, v229
    v_mul_f32 v95, v95, v229
    v_mul_f32 v96, v96, v229
    v_mul_f32 v97, v97, v229
    v_mul_f32 v98, v98, v229
    v_mul_f32 v99, v99, v229
    v_mul_f32 v100, v100, v229
    v_mul_f32 v101, v101, v229
    v_mul_f32 v102, v102, v229
    v_mul_f32 v103, v103, v229
    v_mul_f32 v104, v104, v229
    v_mul_f32 v105, v105, v229
    v_mul_f32 v106, v106, v229
    v_mul_f32 v107, v107, v229
    v_mul_f32 v108, v108, v229
    v_mul_f32 v109, v109, v229
    v_mul_f32 v110, v110, v229
    v_mul_f32 v111, v111, v229
    v_mul_f32 v112, v112, v229
    v_mul_f32 v113, v113, v229
    v_mul_f32 v114, v114, v229
    v_mul_f32 v115, v115, v229
    v_mul_f32 v116, v116, v229
    v_mul_f32 v117, v117, v229
    v_mul_f32 v118, v118, v229
    v_mul_f32 v119, v119, v229
    v_mul_f32 v120, v120, v229
    v_mul_f32 v121, v121, v229
    v_mul_f32 v122, v122, v229
    v_mul_f32 v123, v123, v229
    v_mul_f32 v124, v124, v229
    v_mul_f32 v125, v125, v229
    v_mul_f32 v126, v126, v229
    v_mul_f32 v127, v127, v229
    v_mul_f32 v30, v30, v229
    v_mov_b32 v28, 0
    v_exp_f32 v224, v128
    v_exp_f32 v225, v129
    v_add_f32 v28, v28, v224
    v_add_f32 v28, v28, v225
    v_cvt_pk_bf16_f32 v176, v224, v225
    v_exp_f32 v224, v130
    v_exp_f32 v225, v131
    v_add_f32 v28, v28, v224
    v_add_f32 v28, v28, v225
    v_cvt_pk_bf16_f32 v177, v224, v225
    v_exp_f32 v224, v132
    v_exp_f32 v225, v133
    v_add_f32 v28, v28, v224
    v_add_f32 v28, v28, v225
    v_cvt_pk_bf16_f32 v178, v224, v225
    v_exp_f32 v224, v134
    v_exp_f32 v225, v135
    v_add_f32 v28, v28, v224
    v_add_f32 v28, v28, v225
    v_cvt_pk_bf16_f32 v179, v224, v225
    v_exp_f32 v224, v136
    v_exp_f32 v225, v137
    v_add_f32 v28, v28, v224
    v_add_f32 v28, v28, v225
    v_cvt_pk_bf16_f32 v180, v224, v225
    v_exp_f32 v224, v138
    v_exp_f32 v225, v139
    v_add_f32 v28, v28, v224
    v_add_f32 v28, v28, v225
    v_cvt_pk_bf16_f32 v181, v224, v225
    v_exp_f32 v224, v140
    v_exp_f32 v225, v141
    v_add_f32 v28, v28, v224
    v_add_f32 v28, v28, v225
    v_cvt_pk_bf16_f32 v182, v224, v225
    v_exp_f32 v224, v142
    v_exp_f32 v225, v143
    v_add_f32 v28, v28, v224
    v_add_f32 v28, v28, v225
    v_cvt_pk_bf16_f32 v183, v224, v225
    s_nop 1
    s_branch L_RARE_L4_BACK
L_RARE_L5:
    s_nop 15
    v_max3_f32 v228, v144, v145, v146
    v_max3_f32 v228, v228, v147, v148
    v_max3_f32 v228, v228, v149, v150
    v_max3_f32 v228, v228, v151, v152
    v_max3_f32 v228, v228, v153, v154
    v_max3_f32 v228, v228, v155, v156
    v_max3_f32 v228, v228, v157, v158
    v_max_f32 v228, v228, v159
    v_mov_b32 v31, v228
    s_nop 1
    v_permlane32_swap_b32 v228, v31
    s_nop 1
    v_max_f32 v228, v228, v31
    v_max_f32 v228, 0, v228
    v_exp_f32 v229, -v228
    v_sub_f32 v160, v160, v228
    v_sub_f32 v161, v161, v228
    v_sub_f32 v162, v162, v228
    v_sub_f32 v163, v163, v228
    v_sub_f32 v164, v164, v228
    v_sub_f32 v165, v165, v228
    v_sub_f32 v166, v166, v228
    v_sub_f32 v167, v167, v228
    v_sub_f32 v168, v168, v228
    v_sub_f32 v169, v169, v228
    v_sub_f32 v170, v170, v228
    v_sub_f32 v171, v171, v228
    v_sub_f32 v172, v172, v228
    v_sub_f32 v173, v173, v228
    v_sub_f32 v174, v174, v228
    v_sub_f32 v175, v175, v228
    v_sub_f32 v144, v144, v228
    v_sub_f32 v145, v145, v228
    v_sub_f32 v146, v146, v228
    v_sub_f32 v147, v147, v228
    v_sub_f32 v148, v148, v228
    v_sub_f32 v149, v149, v228
    v_sub_f32 v150, v150, v228
    v_sub_f32 v151, v151, v228
    v_sub_f32 v152, v152, v228
    v_sub_f32 v153, v153, v228
    v_sub_f32 v154, v154, v228
    v_sub_f32 v155, v155, v228
    v_sub_f32 v156, v156, v228
    v_sub_f32 v157, v157, v228
    v_sub_f32 v158, v158, v228
    v_sub_f32 v159, v159, v228
    v_sub_f32 v128, v128, v228
    v_sub_f32 v129, v129, v228
    v_sub_f32 v130, v130, v228
    v_sub_f32 v131, v131, v228
    v_sub_f32 v132, v132, v228
    v_sub_f32 v133, v133, v228
    v_sub_f32 v134, v134, v228
    v_sub_f32 v135, v135, v228
    v_sub_f32 v136, v136, v228
    v_sub_f32 v137, v137, v228
    v_sub_f32 v138, v138, v228
    v_sub_f32 v139, v139, v228
    v_sub_f32 v140, v140, v228
    v_sub_f32 v141, v141, v228
    v_sub_f32 v142, v142, v228
    v_sub_f32 v143, v143, v228
    v_mul_f32 v64, v64, v229
    v_mul_f32 v65, v65, v229
    v_mul_f32 v66, v66, v229
    v_mul_f32 v67, v67, v229
    v_mul_f32 v68, v68, v229
    v_mul_f32 v69, v69, v229
    v_mul_f32 v70, v70, v229
    v_mul_f32 v71, v71, v229
    v_mul_f32 v72, v72, v229
    v_mul_f32 v73, v73, v229
    v_mul_f32 v74, v74, v229
    v_mul_f32 v75, v75, v229
    v_mul_f32 v76, v76, v229
    v_mul_f32 v77, v77, v229
    v_mul_f32 v78, v78, v229
    v_mul_f32 v79, v79, v229
    v_mul_f32 v80, v80, v229
    v_mul_f32 v81, v81, v229
    v_mul_f32 v82, v82, v229
    v_mul_f32 v83, v83, v229
    v_mul_f32 v84, v84, v229
    v_mul_f32 v85, v85, v229
    v_mul_f32 v86, v86, v229
    v_mul_f32 v87, v87, v229
    v_mul_f32 v88, v88, v229
    v_mul_f32 v89, v89, v229
    v_mul_f32 v90, v90, v229
    v_mul_f32 v91, v91, v229
    v_mul_f32 v92, v92, v229
    v_mul_f32 v93, v93, v229
    v_mul_f32 v94, v94, v229
    v_mul_f32 v95, v95, v229
    v_mul_f32 v96, v96, v229
    v_mul_f32 v97, v97, v229
    v_mul_f32 v98, v98, v229
    v_mul_f32 v99, v99, v229
    v_mul_f32 v100, v100, v229
    v_mul_f32 v101, v101, v229
    v_mul_f32 v102, v102, v229
    v_mul_f32 v103, v103, v229
    v_mul_f32 v104, v104, v229
    v_mul_f32 v105, v105, v229
    v_mul_f32 v106, v106, v229
    v_mul_f32 v107, v107, v229
    v_mul_f32 v108, v108, v229
    v_mul_f32 v109, v109, v229
    v_mul_f32 v110, v110, v229
    v_mul_f32 v111, v111, v229
    v_mul_f32 v112, v112, v229
    v_mul_f32 v113, v113, v229
    v_mul_f32 v114, v114, v229
    v_mul_f32 v115, v115, v229
    v_mul_f32 v116, v116, v229
    v_mul_f32 v117, v117, v229
    v_mul_f32 v118, v118, v229
    v_mul_f32 v119, v119, v229
    v_mul_f32 v120, v120, v229
    v_mul_f32 v121, v121, v229
    v_mul_f32 v122, v122, v229
    v_mul_f32 v123, v123, v229
    v_mul_f32 v124, v124, v229
    v_mul_f32 v125, v125, v229
    v_mul_f32 v126, v126, v229
    v_mul_f32 v127, v127, v229
    v_mul_f32 v30, v30, v229
    v_mov_b32 v28, 0
    v_exp_f32 v224, v144
    v_exp_f32 v225, v145
    v_add_f32 v28, v28, v224
    v_add_f32 v28, v28, v225
    v_cvt_pk_bf16_f32 v184, v224, v225
    v_exp_f32 v224, v146
    v_exp_f32 v225, v147
    v_add_f32 v28, v28, v224
    v_add_f32 v28, v28, v225
    v_cvt_pk_bf16_f32 v185, v224, v225
    v_exp_f32 v224, v148
    v_exp_f32 v225, v149
    v_add_f32 v28, v28, v224
    v_add_f32 v28, v28, v225
    v_cvt_pk_bf16_f32 v186, v224, v225
    v_exp_f32 v224, v150
    v_exp_f32 v225, v151
    v_add_f32 v28, v28, v224
    v_add_f32 v28, v28, v225
    v_cvt_pk_bf16_f32 v187, v224, v225
    v_exp_f32 v224, v152
    v_exp_f32 v225, v153
    v_add_f32 v28, v28, v224
    v_add_f32 v28, v28, v225
    v_cvt_pk_bf16_f32 v188, v224, v225
    v_exp_f32 v224, v154
    v_exp_f32 v225, v155
    v_add_f32 v28, v28, v224
    v_add_f32 v28, v28, v225
    v_cvt_pk_bf16_f32 v189, v224, v225
    v_exp_f32 v224, v156
    v_exp_f32 v225, v157
    v_add_f32 v28, v28, v224
    v_add_f32 v28, v28, v225
    v_cvt_pk_bf16_f32 v190, v224, v225
    v_exp_f32 v224, v158
    v_exp_f32 v225, v159
    v_add_f32 v28, v28, v224
    v_add_f32 v28, v28, v225
    v_cvt_pk_bf16_f32 v191, v224, v225
    s_nop 1
    s_branch L_RARE_L5_BACK
L_RARE_L6:
    s_nop 15
    v_max3_f32 v228, v128, v129, v130
    v_max3_f32 v228, v228, v131, v132
    v_max3_f32 v228, v228, v133, v134
    v_max3_f32 v228, v228, v135, v136
    v_max3_f32 v228, v228, v137, v138
    v_max3_f32 v228, v228, v139, v140
    v_max3_f32 v228, v228, v141, v142
    v_max_f32 v228, v228, v143
    v_mov_b32 v31, v228
    s_nop 1
    v_permlane32_swap_b32 v228, v31
    s_nop 1
    v_max_f32 v228, v228, v31
    v_max_f32 v228, 0, v228
    v_exp_f32 v229, -v228
    v_sub_f32 v160, v160, v228
    v_sub_f32 v161, v161, v228
    v_sub_f32 v162, v162, v228
    v_sub_f32 v163, v163, v228
    v_sub_f32 v164, v164, v228
    v_sub_f32 v165, v165, v228
    v_sub_f32 v166, v166, v228
    v_sub_f32 v167, v167, v228
    v_sub_f32 v168, v168, v228
    v_sub_f32 v169, v169, v228
    v_sub_f32 v170, v170, v228
    v_sub_f32 v171, v171, v228
    v_sub_f32 v172, v172, v228
    v_sub_f32 v173, v173, v228
    v_sub_f32 v174, v174, v228
    v_sub_f32 v175, v175, v228
    v_sub_f32 v128, v128, v228
    v_sub_f32 v129, v129, v228
    v_sub_f32 v130, v130, v228
    v_sub_f32 v131, v131, v228
    v_sub_f32 v132, v132, v228
    v_sub_f32 v133, v133, v228
    v_sub_f32 v134, v134, v228
    v_sub_f32 v135, v135, v228
    v_sub_f32 v136, v136, v228
    v_sub_f32 v137, v137, v228
    v_sub_f32 v138, v138, v228
    v_sub_f32 v139, v139, v228
    v_sub_f32 v140, v140, v228
    v_sub_f32 v141, v141, v228
    v_sub_f32 v142, v142, v228
    v_sub_f32 v143, v143, v228
    v_sub_f32 v144, v144, v228
    v_sub_f32 v145, v145, v228
    v_sub_f32 v146, v146, v228
    v_sub_f32 v147, v147, v228
    v_sub_f32 v148, v148, v228
    v_sub_f32 v149, v149, v228
    v_sub_f32 v150, v150, v228
    v_sub_f32 v151, v151, v228
    v_sub_f32 v152, v152, v228
    v_sub_f32 v153, v153, v228
    v_sub_f32 v154, v154, v228
    v_sub_f32 v155, v155, v228
    v_sub_f32 v156, v156, v228
    v_sub_f32 v157, v157, v228
    v_sub_f32 v158, v158, v228
    v_sub_f32 v159, v159, v228
    v_mul_f32 v64, v64, v229
    v_mul_f32 v65, v65, v229
    v_mul_f32 v66, v66, v229
    v_mul_f32 v67, v67, v229
    v_mul_f32 v68, v68, v229
    v_mul_f32 v69, v69, v229
    v_mul_f32 v70, v70, v229
    v_mul_f32 v71, v71, v229
    v_mul_f32 v72, v72, v229
    v_mul_f32 v73, v73, v229
    v_mul_f32 v74, v74, v229
    v_mul_f32 v75, v75, v229
    v_mul_f32 v76, v76, v229
    v_mul_f32 v77, v77, v229
    v_mul_f32 v78, v78, v229
    v_mul_f32 v79, v79, v229
    v_mul_f32 v80, v80, v229
    v_mul_f32 v81, v81, v229
    v_mul_f32 v82, v82, v229
    v_mul_f32 v83, v83, v229
    v_mul_f32 v84, v84, v229
    v_mul_f32 v85, v85, v229
    v_mul_f32 v86, v86, v229
    v_mul_f32 v87, v87, v229
    v_mul_f32 v88, v88, v229
    v_mul_f32 v89, v89, v229
    v_mul_f32 v90, v90, v229
    v_mul_f32 v91, v91, v229
    v_mul_f32 v92, v92, v229
    v_mul_f32 v93, v93, v229
    v_mul_f32 v94, v94, v229
    v_mul_f32 v95, v95, v229
    v_mul_f32 v96, v96, v229
    v_mul_f32 v97, v97, v229
    v_mul_f32 v98, v98, v229
    v_mul_f32 v99, v99, v229
    v_mul_f32 v100, v100, v229
    v_mul_f32 v101, v101, v229
    v_mul_f32 v102, v102, v229
    v_mul_f32 v103, v103, v229
    v_mul_f32 v104, v104, v229
    v_mul_f32 v105, v105, v229
    v_mul_f32 v106, v106, v229
    v_mul_f32 v107, v107, v229
    v_mul_f32 v108, v108, v229
    v_mul_f32 v109, v109, v229
    v_mul_f32 v110, v110, v229
    v_mul_f32 v111, v111, v229
    v_mul_f32 v112, v112, v229
    v_mul_f32 v113, v113, v229
    v_mul_f32 v114, v114, v229
    v_mul_f32 v115, v115, v229
    v_mul_f32 v116, v116, v229
    v_mul_f32 v117, v117, v229
    v_mul_f32 v118, v118, v229
    v_mul_f32 v119, v119, v229
    v_mul_f32 v120, v120, v229
    v_mul_f32 v121, v121, v229
    v_mul_f32 v122, v122, v229
    v_mul_f32 v123, v123, v229
    v_mul_f32 v124, v124, v229
    v_mul_f32 v125, v125, v229
    v_mul_f32 v126, v126, v229
    v_mul_f32 v127, v127, v229
    v_mul_f32 v30, v30, v229
    v_mov_b32 v28, 0
    v_exp_f32 v224, v128
    v_exp_f32 v225, v129
    v_add_f32 v28, v28, v224
    v_add_f32 v28, v28, v225
    v_cvt_pk_bf16_f32 v176, v224, v225
    v_exp_f32 v224, v130
    v_exp_f32 v225, v131
    v_add_f32 v28, v28, v224
    v_add_f32 v28, v28, v225
    v_cvt_pk_bf16_f32 v177, v224, v225
    v_exp_f32 v224, v132
    v_exp_f32 v225, v133
    v_add_f32 v28, v28, v224
    v_add_f32 v28, v28, v225
    v_cvt_pk_bf16_f32 v178, v224, v225
    v_exp_f32 v224, v134
    v_exp_f32 v225, v135
    v_add_f32 v28, v28, v224
    v_add_f32 v28, v28, v225
    v_cvt_pk_bf16_f32 v179, v224, v225
    v_exp_f32 v224, v136
    v_exp_f32 v225, v137
    v_add_f32 v28, v28, v224
    v_add_f32 v28, v28, v225
    v_cvt_pk_bf16_f32 v180, v224, v225
    v_exp_f32 v224, v138
    v_exp_f32 v225, v139
    v_add_f32 v28, v28, v224
    v_add_f32 v28, v28, v225
    v_cvt_pk_bf16_f32 v181, v224, v225
    v_exp_f32 v224, v140
    v_exp_f32 v225, v141
    v_add_f32 v28, v28, v224
    v_add_f32 v28, v28, v225
    v_cvt_pk_bf16_f32 v182, v224, v225
    v_exp_f32 v224, v142
    v_exp_f32 v225, v143
    v_add_f32 v28, v28, v224
    v_add_f32 v28, v28, v225
    v_cvt_pk_bf16_f32 v183, v224, v225
    s_nop 1
    s_branch L_RARE_L6_BACK
L_RARE_L7:
    s_nop 15
    v_max3_f32 v228, v144, v145, v146
    v_max3_f32 v228, v228, v147, v148
    v_max3_f32 v228, v228, v149, v150
    v_max3_f32 v228, v228, v151, v152
    v_max3_f32 v228, v228, v153, v154
    v_max3_f32 v228, v228, v155, v156
    v_max3_f32 v228, v228, v157, v158
    v_max_f32 v228, v228, v159
    v_mov_b32 v31, v228
    s_nop 1
    v_permlane32_swap_b32 v228, v31
    s_nop 1
    v_max_f32 v228, v228, v31
    v_max_f32 v228, 0, v228
    v_exp_f32 v229, -v228
    v_sub_f32 v160, v160, v228
    v_sub_f32 v161, v161, v228
    v_sub_f32 v162, v162, v228
    v_sub_f32 v163, v163, v228
    v_sub_f32 v164, v164, v228
    v_sub_f32 v165, v165, v228
    v_sub_f32 v166, v166, v228
    v_sub_f32 v167, v167, v228
    v_sub_f32 v168, v168, v228
    v_sub_f32 v169, v169, v228
    v_sub_f32 v170, v170, v228
    v_sub_f32 v171, v171, v228
    v_sub_f32 v172, v172, v228
    v_sub_f32 v173, v173, v228
    v_sub_f32 v174, v174, v228
    v_sub_f32 v175, v175, v228
    v_sub_f32 v144, v144, v228
    v_sub_f32 v145, v145, v228
    v_sub_f32 v146, v146, v228
    v_sub_f32 v147, v147, v228
    v_sub_f32 v148, v148, v228
    v_sub_f32 v149, v149, v228
    v_sub_f32 v150, v150, v228
    v_sub_f32 v151, v151, v228
    v_sub_f32 v152, v152, v228
    v_sub_f32 v153, v153, v228
    v_sub_f32 v154, v154, v228
    v_sub_f32 v155, v155, v228
    v_sub_f32 v156, v156, v228
    v_sub_f32 v157, v157, v228
    v_sub_f32 v158, v158, v228
    v_sub_f32 v159, v159, v228
    v_sub_f32 v128, v128, v228
    v_sub_f32 v129, v129, v228
    v_sub_f32 v130, v130, v228
    v_sub_f32 v131, v131, v228
    v_sub_f32 v132, v132, v228
    v_sub_f32 v133, v133, v228
    v_sub_f32 v134, v134, v228
    v_sub_f32 v135, v135, v228
    v_sub_f32 v136, v136, v228
    v_sub_f32 v137, v137, v228
    v_sub_f32 v138, v138, v228
    v_sub_f32 v139, v139, v228
    v_sub_f32 v140, v140, v228
    v_sub_f32 v141, v141, v228
    v_sub_f32 v142, v142, v228
    v_sub_f32 v143, v143, v228
    v_mul_f32 v64, v64, v229
    v_mul_f32 v65, v65, v229
    v_mul_f32 v66, v66, v229
    v_mul_f32 v67, v67, v229
    v_mul_f32 v68, v68, v229
    v_mul_f32 v69, v69, v229
    v_mul_f32 v70, v70, v229
    v_mul_f32 v71, v71, v229
    v_mul_f32 v72, v72, v229
    v_mul_f32 v73, v73, v229
    v_mul_f32 v74, v74, v229
    v_mul_f32 v75, v75, v229
    v_mul_f32 v76, v76, v229
    v_mul_f32 v77, v77, v229
    v_mul_f32 v78, v78, v229
    v_mul_f32 v79, v79, v229
    v_mul_f32 v80, v80, v229
    v_mul_f32 v81, v81, v229
    v_mul_f32 v82, v82, v229
    v_mul_f32 v83, v83, v229
    v_mul_f32 v84, v84, v229
    v_mul_f32 v85, v85, v229
    v_mul_f32 v86, v86, v229
    v_mul_f32 v87, v87, v229
    v_mul_f32 v88, v88, v229
    v_mul_f32 v89, v89, v229
    v_mul_f32 v90, v90, v229
    v_mul_f32 v91, v91, v229
    v_mul_f32 v92, v92, v229
    v_mul_f32 v93, v93, v229
    v_mul_f32 v94, v94, v229
    v_mul_f32 v95, v95, v229
    v_mul_f32 v96, v96, v229
    v_mul_f32 v97, v97, v229
    v_mul_f32 v98, v98, v229
    v_mul_f32 v99, v99, v229
    v_mul_f32 v100, v100, v229
    v_mul_f32 v101, v101, v229
    v_mul_f32 v102, v102, v229
    v_mul_f32 v103, v103, v229
    v_mul_f32 v104, v104, v229
    v_mul_f32 v105, v105, v229
    v_mul_f32 v106, v106, v229
    v_mul_f32 v107, v107, v229
    v_mul_f32 v108, v108, v229
    v_mul_f32 v109, v109, v229
    v_mul_f32 v110, v110, v229
    v_mul_f32 v111, v111, v229
    v_mul_f32 v112, v112, v229
    v_mul_f32 v113, v113, v229
    v_mul_f32 v114, v114, v229
    v_mul_f32 v115, v115, v229
    v_mul_f32 v116, v116, v229
    v_mul_f32 v117, v117, v229
    v_mul_f32 v118, v118, v229
    v_mul_f32 v119, v119, v229
    v_mul_f32 v120, v120, v229
    v_mul_f32 v121, v121, v229
    v_mul_f32 v122, v122, v229
    v_mul_f32 v123, v123, v229
    v_mul_f32 v124, v124, v229
    v_mul_f32 v125, v125, v229
    v_mul_f32 v126, v126, v229
    v_mul_f32 v127, v127, v229
    v_mul_f32 v30, v30, v229
    v_mov_b32 v28, 0
    v_exp_f32 v224, v144
    v_exp_f32 v225, v145
    v_add_f32 v28, v28, v224
    v_add_f32 v28, v28, v225
    v_cvt_pk_bf16_f32 v184, v224, v225
    v_exp_f32 v224, v146
    v_exp_f32 v225, v147
    v_add_f32 v28, v28, v224
    v_add_f32 v28, v28, v225
    v_cvt_pk_bf16_f32 v185, v224, v225
    v_exp_f32 v224, v148
    v_exp_f32 v225, v149
    v_add_f32 v28, v28, v224
    v_add_f32 v28, v28, v225
    v_cvt_pk_bf16_f32 v186, v224, v225
    v_exp_f32 v224, v150
    v_exp_f32 v225, v151
    v_add_f32 v28, v28, v224
    v_add_f32 v28, v28, v225
    v_cvt_pk_bf16_f32 v187, v224, v225
    v_exp_f32 v224, v152
    v_exp_f32 v225, v153
    v_add_f32 v28, v28, v224
    v_add_f32 v28, v28, v225
    v_cvt_pk_bf16_f32 v188, v224, v225
    v_exp_f32 v224, v154
    v_exp_f32 v225, v155
    v_add_f32 v28, v28, v224
    v_add_f32 v28, v28, v225
    v_cvt_pk_bf16_f32 v189, v224, v225
    v_exp_f32 v224, v156
    v_exp_f32 v225, v157
    v_add_f32 v28, v28, v224
    v_add_f32 v28, v28, v225
    v_cvt_pk_bf16_f32 v190, v224, v225
    v_exp_f32 v224, v158
    v_exp_f32 v225, v159
    v_add_f32 v28, v28, v224
    v_add_f32 v28, v28, v225
    v_cvt_pk_bf16_f32 v191, v224, v225
    s_nop 1
    s_branch L_RARE_L7_BACK
L_RARE_L8:
    s_nop 15
    v_max3_f32 v228, v128, v129, v130
    v_max3_f32 v228, v228, v131, v132
    v_max3_f32 v228, v228, v133, v134
    v_max3_f32 v228, v228, v135, v136
    v_max3_f32 v228, v228, v137, v138
    v_max3_f32 v228, v228, v139, v140
    v_max3_f32 v228, v228, v141, v142
    v_max_f32 v228, v228, v143
    v_mov_b32 v31, v228
    s_nop 1
    v_permlane32_swap_b32 v228, v31
    s_nop 1
    v_max_f32 v228, v228, v31
    v_max_f32 v228, 0, v228
    v_exp_f32 v229, -v228
    v_sub_f32 v160, v160, v228
    v_sub_f32 v161, v161, v228
    v_sub_f32 v162, v162, v228
    v_sub_f32 v163, v163, v228
    v_sub_f32 v164, v164, v228
    v_sub_f32 v165, v165, v228
    v_sub_f32 v166, v166, v228
    v_sub_f32 v167, v167, v228
    v_sub_f32 v168, v168, v228
    v_sub_f32 v169, v169, v228
    v_sub_f32 v170, v170, v228
    v_sub_f32 v171, v171, v228
    v_sub_f32 v172, v172, v228
    v_sub_f32 v173, v173, v228
    v_sub_f32 v174, v174, v228
    v_sub_f32 v175, v175, v228
    v_sub_f32 v128, v128, v228
    v_sub_f32 v129, v129, v228
    v_sub_f32 v130, v130, v228
    v_sub_f32 v131, v131, v228
    v_sub_f32 v132, v132, v228
    v_sub_f32 v133, v133, v228
    v_sub_f32 v134, v134, v228
    v_sub_f32 v135, v135, v228
    v_sub_f32 v136, v136, v228
    v_sub_f32 v137, v137, v228
    v_sub_f32 v138, v138, v228
    v_sub_f32 v139, v139, v228
    v_sub_f32 v140, v140, v228
    v_sub_f32 v141, v141, v228
    v_sub_f32 v142, v142, v228
    v_sub_f32 v143, v143, v228
    v_sub_f32 v144, v144, v228
    v_sub_f32 v145, v145, v228
    v_sub_f32 v146, v146, v228
    v_sub_f32 v147, v147, v228
    v_sub_f32 v148, v148, v228
    v_sub_f32 v149, v149, v228
    v_sub_f32 v150, v150, v228
    v_sub_f32 v151, v151, v228
    v_sub_f32 v152, v152, v228
    v_sub_f32 v153, v153, v228
    v_sub_f32 v154, v154, v228
    v_sub_f32 v155, v155, v228
    v_sub_f32 v156, v156, v228
    v_sub_f32 v157, v157, v228
    v_sub_f32 v158, v158, v228
    v_sub_f32 v159, v159, v228
    v_mul_f32 v64, v64, v229
    v_mul_f32 v65, v65, v229
    v_mul_f32 v66, v66, v229
    v_mul_f32 v67, v67, v229
    v_mul_f32 v68, v68, v229
    v_mul_f32 v69, v69, v229
    v_mul_f32 v70, v70, v229
    v_mul_f32 v71, v71, v229
    v_mul_f32 v72, v72, v229
    v_mul_f32 v73, v73, v229
    v_mul_f32 v74, v74, v229
    v_mul_f32 v75, v75, v229
    v_mul_f32 v76, v76, v229
    v_mul_f32 v77, v77, v229
    v_mul_f32 v78, v78, v229
    v_mul_f32 v79, v79, v229
    v_mul_f32 v80, v80, v229
    v_mul_f32 v81, v81, v229
    v_mul_f32 v82, v82, v229
    v_mul_f32 v83, v83, v229
    v_mul_f32 v84, v84, v229
    v_mul_f32 v85, v85, v229
    v_mul_f32 v86, v86, v229
    v_mul_f32 v87, v87, v229
    v_mul_f32 v88, v88, v229
    v_mul_f32 v89, v89, v229
    v_mul_f32 v90, v90, v229
    v_mul_f32 v91, v91, v229
    v_mul_f32 v92, v92, v229
    v_mul_f32 v93, v93, v229
    v_mul_f32 v94, v94, v229
    v_mul_f32 v95, v95, v229
    v_mul_f32 v96, v96, v229
    v_mul_f32 v97, v97, v229
    v_mul_f32 v98, v98, v229
    v_mul_f32 v99, v99, v229
    v_mul_f32 v100, v100, v229
    v_mul_f32 v101, v101, v229
    v_mul_f32 v102, v102, v229
    v_mul_f32 v103, v103, v229
    v_mul_f32 v104, v104, v229
    v_mul_f32 v105, v105, v229
    v_mul_f32 v106, v106, v229
    v_mul_f32 v107, v107, v229
    v_mul_f32 v108, v108, v229
    v_mul_f32 v109, v109, v229
    v_mul_f32 v110, v110, v229
    v_mul_f32 v111, v111, v229
    v_mul_f32 v112, v112, v229
    v_mul_f32 v113, v113, v229
    v_mul_f32 v114, v114, v229
    v_mul_f32 v115, v115, v229
    v_mul_f32 v116, v116, v229
    v_mul_f32 v117, v117, v229
    v_mul_f32 v118, v118, v229
    v_mul_f32 v119, v119, v229
    v_mul_f32 v120, v120, v229
    v_mul_f32 v121, v121, v229
    v_mul_f32 v122, v122, v229
    v_mul_f32 v123, v123, v229
    v_mul_f32 v124, v124, v229
    v_mul_f32 v125, v125, v229
    v_mul_f32 v126, v126, v229
    v_mul_f32 v127, v127, v229
    v_mul_f32 v30, v30, v229
    v_mov_b32 v28, 0
    v_exp_f32 v224, v128
    v_exp_f32 v225, v129
    v_add_f32 v28, v28, v224
    v_add_f32 v28, v28, v225
    v_cvt_pk_bf16_f32 v176, v224, v225
    v_exp_f32 v224, v130
    v_exp_f32 v225, v131
    v_add_f32 v28, v28, v224
    v_add_f32 v28, v28, v225
    v_cvt_pk_bf16_f32 v177, v224, v225
    v_exp_f32 v224, v132
    v_exp_f32 v225, v133
    v_add_f32 v28, v28, v224
    v_add_f32 v28, v28, v225
    v_cvt_pk_bf16_f32 v178, v224, v225
    v_exp_f32 v224, v134
    v_exp_f32 v225, v135
    v_add_f32 v28, v28, v224
    v_add_f32 v28, v28, v225
    v_cvt_pk_bf16_f32 v179, v224, v225
    v_exp_f32 v224, v136
    v_exp_f32 v225, v137
    v_add_f32 v28, v28, v224
    v_add_f32 v28, v28, v225
    v_cvt_pk_bf16_f32 v180, v224, v225
    v_exp_f32 v224, v138
    v_exp_f32 v225, v139
    v_add_f32 v28, v28, v224
    v_add_f32 v28, v28, v225
    v_cvt_pk_bf16_f32 v181, v224, v225
    v_exp_f32 v224, v140
    v_exp_f32 v225, v141
    v_add_f32 v28, v28, v224
    v_add_f32 v28, v28, v225
    v_cvt_pk_bf16_f32 v182, v224, v225
    v_exp_f32 v224, v142
    v_exp_f32 v225, v143
    v_add_f32 v28, v28, v224
    v_add_f32 v28, v28, v225
    v_cvt_pk_bf16_f32 v183, v224, v225
    s_nop 1
    s_branch L_RARE_L8_BACK
L_RARE_31:
    s_nop 15
    v_max3_f32 v228, v144, v145, v146
    v_max3_f32 v228, v228, v147, v148
    v_max3_f32 v228, v228, v149, v150
    v_max3_f32 v228, v228, v151, v152
    v_max3_f32 v228, v228, v153, v154
    v_max3_f32 v228, v228, v155, v156
    v_max3_f32 v228, v228, v157, v158
    v_max_f32 v228, v228, v159
    v_mov_b32 v31, v228
    s_nop 1
    v_permlane32_swap_b32 v228, v31
    s_nop 1
    v_max_f32 v228, v228, v31
    v_max_f32 v228, 0, v228
    v_exp_f32 v229, -v228
    v_sub_f32 v160, v160, v228
    v_sub_f32 v161, v161, v228
    v_sub_f32 v162, v162, v228
    v_sub_f32 v163, v163, v228
    v_sub_f32 v164, v164, v228
    v_sub_f32 v165, v165, v228
    v_sub_f32 v166, v166, v228
    v_sub_f32 v167, v167, v228
    v_sub_f32 v168, v168, v228
    v_sub_f32 v169, v169, v228
    v_sub_f32 v170, v170, v228
    v_sub_f32 v171, v171, v228
    v_sub_f32 v172, v172, v228
    v_sub_f32 v173, v173, v228
    v_sub_f32 v174, v174, v228
    v_sub_f32 v175, v175, v228
    v_sub_f32 v144, v144, v228
    v_sub_f32 v145, v145, v228
    v_sub_f32 v146, v146, v228
    v_sub_f32 v147, v147, v228
    v_sub_f32 v148, v148, v228
    v_sub_f32 v149, v149, v228
    v_sub_f32 v150, v150, v228
    v_sub_f32 v151, v151, v228
    v_sub_f32 v152, v152, v228
    v_sub_f32 v153, v153, v228
    v_sub_f32 v154, v154, v228
    v_sub_f32 v155, v155, v228
    v_sub_f32 v156, v156, v228
    v_sub_f32 v157, v157, v228
    v_sub_f32 v158, v158, v228
    v_sub_f32 v159, v159, v228
    v_mul_f32 v64, v64, v229
    v_mul_f32 v65, v65, v229
    v_mul_f32 v66, v66, v229
    v_mul_f32 v67, v67, v229
    v_mul_f32 v68, v68, v229
    v_mul_f32 v69, v69, v229
    v_mul_f32 v70, v70, v229
    v_mul_f32 v71, v71, v229
    v_mul_f32 v72, v72, v229
    v_mul_f32 v73, v73, v229
    v_mul_f32 v74, v74, v229
    v_mul_f32 v75, v75, v229
    v_mul_f32 v76, v76, v229
    v_mul_f32 v77, v77, v229
    v_mul_f32 v78, v78, v229
    v_mul_f32 v79, v79, v229
    v_mul_f32 v80, v80, v229
    v_mul_f32 v81, v81, v229
    v_mul_f32 v82, v82, v229
    v_mul_f32 v83, v83, v229
    v_mul_f32 v84, v84, v229
    v_mul_f32 v85, v85, v229
    v_mul_f32 v86, v86, v229
    v_mul_f32 v87, v87, v229
    v_mul_f32 v88, v88, v229
    v_mul_f32 v89, v89, v229
    v_mul_f32 v90, v90, v229
    v_mul_f32 v91, v91, v229
    v_mul_f32 v92, v92, v229
    v_mul_f32 v93, v93, v229
    v_mul_f32 v94, v94, v229
    v_mul_f32 v95, v95, v229
    v_mul_f32 v96, v96, v229
    v_mul_f32 v97, v97, v229
    v_mul_f32 v98, v98, v229
    v_mul_f32 v99, v99, v229
    v_mul_f32 v100, v100, v229
    v_mul_f32 v101, v101, v229
    v_mul_f32 v102, v102, v229
    v_mul_f32 v103, v103, v229
    v_mul_f32 v104, v104, v229
    v_mul_f32 v105, v105, v229
    v_mul_f32 v106, v106, v229
    v_mul_f32 v107, v107, v229
    v_mul_f32 v108, v108, v229
    v_mul_f32 v109, v109, v229
    v_mul_f32 v110, v110, v229
    v_mul_f32 v111, v111, v229
    v_mul_f32 v112, v112, v229
    v_mul_f32 v113, v113, v229
    v_mul_f32 v114, v114, v229
    v_mul_f32 v115, v115, v229
    v_mul_f32 v116, v116, v229
    v_mul_f32 v117, v117, v229
    v_mul_f32 v118, v118, v229
    v_mul_f32 v119, v119, v229
    v_mul_f32 v120, v120, v229
    v_mul_f32 v121, v121, v229
    v_mul_f32 v122, v122, v229
    v_mul_f32 v123, v123, v229
    v_mul_f32 v124, v124, v229
    v_mul_f32 v125, v125, v229
    v_mul_f32 v126, v126, v229
    v_mul_f32 v127, v127, v229
    v_mul_f32 v30, v30, v229
    v_mov_b32 v28, 0
    v_exp_f32 v224, v144
    v_exp_f32 v225, v145
    v_add_f32 v28, v28, v224
    v_add_f32 v28, v28, v225
    v_cvt_pk_bf16_f32 v184, v224, v225
    v_exp_f32 v224, v146
    v_exp_f32 v225, v147
    v_add_f32 v28, v28, v224
    v_add_f32 v28, v28, v225
    v_cvt_pk_bf16_f32 v185, v224, v225
    v_exp_f32 v224, v148
    v_exp_f32 v225, v149
    v_add_f32 v28, v28, v224
    v_add_f32 v28, v28, v225
    v_cvt_pk_bf16_f32 v186, v224, v225
    v_exp_f32 v224, v150
    v_exp_f32 v225, v151
    v_add_f32 v28, v28, v224
    v_add_f32 v28, v28, v225
    v_cvt_pk_bf16_f32 v187, v224, v225
    v_exp_f32 v224, v152
    v_exp_f32 v225, v153
    v_add_f32 v28, v28, v224
    v_add_f32 v28, v28, v225
    v_cvt_pk_bf16_f32 v188, v224, v225
    v_exp_f32 v224, v154
    v_exp_f32 v225, v155
    v_add_f32 v28, v28, v224
    v_add_f32 v28, v28, v225
    v_cvt_pk_bf16_f32 v189, v224, v225
    v_exp_f32 v224, v156
    v_exp_f32 v225, v157
    v_add_f32 v28, v28, v224
    v_add_f32 v28, v28, v225
    v_cvt_pk_bf16_f32 v190, v224, v225
    v_exp_f32 v224, v158
    v_exp_f32 v225, v159
    v_add_f32 v28, v28, v224
    v_add_f32 v28, v28, v225
    v_cvt_pk_bf16_f32 v191, v224, v225
    s_nop 1
    s_branch L_RARE_31_BACK
.section .rodata,"a"
.p2align 6
.amdhsa_kernel concat_heads__gqa_block_cached__gqa_block_cached__near_ridge_kernel
  .amdhsa_next_free_vgpr 252
  .amdhsa_next_free_sgpr 102
  .amdhsa_accum_offset 252
  .amdhsa_group_segment_fixed_size 0
  .amdhsa_kernarg_size 104
  .amdhsa_user_sgpr_count 2
  .amdhsa_user_sgpr_kernarg_segment_ptr 1
  .amdhsa_system_sgpr_workgroup_id_x 1
.end_amdhsa_kernel
```
